```python
import torch

def _softmax(x, axis=-1):
    return torch.softmax(x, dim=axis)
def _gelu(x):
    return torch.nn.functional.gelu(x, approximate="tanh")
def _silu(x):
    return torch.nn.functional.silu(x)
def _sigmoid(x):
    return torch.sigmoid(x)
def _layernorm(x, axis=-1, eps=1e-5):
    m = x.mean(dim=axis, keepdim=True)
    v = x.var(dim=axis, keepdim=True, unbiased=False)
    return (x - m) / torch.sqrt(v + eps)
def _scatter_add(tgt, idx, src, axis=0):
    return tgt.clone().index_add_(axis, idx, src)
def _segment_sum(src, seg, n):
    out = torch.zeros((n,) + src.shape[1:], dtype=src.dtype)
    return out.index_add_(0, seg, src)
def _pad(x, pw):
    flat = tuple(v for pair in reversed(pw) for v in pair)
    return torch.nn.functional.pad(x, flat)

kernel_name = 'concat_heads__gqa_block_cached__sliding_block_cached__decode'

def setup_inputs():

    _w = (lambda a: (lambda t: t.to(torch.bfloat16) if t.is_floating_point() else t)(torch.as_tensor(a)))
    def _A_setup():
        B, Sq, D = 1, 1, 512
        Hq, Hkv, Sk, Dh = 32, 8, 32768, 128
        assert Hq % Hkv == 0, (Hq, Hkv)
        return {
            "x": _w((lambda *s: torch.randn(*s, dtype=torch.bfloat16) * 0.8)(B, Sq, D)),
            "k_cache": _w((lambda *s: torch.randn(*s, dtype=torch.bfloat16) * 1.6)(B, Hkv, Sk, Dh)),
            "v_cache": _w((lambda *s: torch.randn(*s, dtype=torch.bfloat16) * 0.2)(B, Hkv, Sk, Dh)),
            "wq": _w((lambda *s: torch.randn(*s, dtype=torch.bfloat16) * 1.6)(D, Hq * Dh) * (D ** -0.5)),
            "wo": _w((lambda *s: torch.randn(*s, dtype=torch.bfloat16) * 0.2)(Hq * Dh, D) * ((Hq * Dh) ** -0.5)),
        }
    _A_in = _A_setup()

    def _B_setup():
        B, Sq, D = 1, 1, 512
        Hq, Hkv, Sk, Dh = 32, 8, 32768, 128
        assert Hq % Hkv == 0, (Hq, Hkv)
        return {
            "x": _w((lambda *s: torch.randn(*s, dtype=torch.bfloat16) * 0.8)(B, Sq, D)),
            "k_cache": _w((lambda *s: torch.randn(*s, dtype=torch.bfloat16) * 1.6)(B, Hkv, Sk, Dh)),
            "v_cache": _w((lambda *s: torch.randn(*s, dtype=torch.bfloat16) * 0.2)(B, Hkv, Sk, Dh)),
            "wq": _w((lambda *s: torch.randn(*s, dtype=torch.bfloat16) * 1.6)(D, Hq * Dh) * (D ** -0.5)),
            "wo": _w((lambda *s: torch.randn(*s, dtype=torch.bfloat16) * 0.2)(Hq * Dh, D) * ((Hq * Dh) ** -0.5)),
        }
    _B_in = _B_setup()

    return {
        "A_x": _A_in["x"],
        "A_k_cache": _A_in["k_cache"],
        "A_v_cache": _A_in["v_cache"],
        "A_wq": _A_in["wq"],
        "A_wo": _A_in["wo"],
        "B_x": _B_in["x"],
        "B_k_cache": _B_in["k_cache"],
        "B_v_cache": _B_in["v_cache"],
        "B_wq": _B_in["wq"],
        "B_wo": _B_in["wo"],
    }

def reference(A_x, A_k_cache, A_v_cache, A_wq, A_wo, B_x, B_k_cache, B_v_cache, B_wq, B_wo):
    def _A_ref(x, k_cache, v_cache, wq, wo):
        B, Sq, D = x.shape
        Hq, Dh = 32, 128
        Hkv = k_cache.shape[1]
        rep = Hq // Hkv
        q = (lambda x, *d: x.permute(*d))((x @ wq).reshape(B, Sq, Hq, Dh), 0, 2, 1, 3)
        k = (lambda x, n, axis: torch.repeat_interleave(x, n, dim=axis))(k_cache, rep, axis=1)
        v = (lambda x, n, axis: torch.repeat_interleave(x, n, dim=axis))(v_cache, rep, axis=1)
        scores = torch.einsum("bhqd,bhkd->bhqk", q, k) * (Dh ** -0.5)
        p = _softmax(scores, axis=-1)
        o = torch.einsum("bhqk,bhkd->bhqd", p, v)
        return (lambda x, *d: x.permute(*d))(o, 0, 2, 1, 3).reshape(B, Sq, Hq * Dh) @ wo

    def _B_ref(x, k_cache, v_cache, wq, wo):
        B, Sq, D = x.shape
        Hq, Dh = 32, 128
        Hkv, Sk = k_cache.shape[1], k_cache.shape[2]
        W = min(4096, max(256, Sk // 4))
        rep = Hq // Hkv
        q = (lambda x, *d: x.permute(*d))((x @ wq).reshape(B, Sq, Hq, Dh), 0, 2, 1, 3)
        k = (lambda x, n, axis: torch.repeat_interleave(x, n, dim=axis))(k_cache[:, :, Sk - W:, :], rep, axis=1)
        v = (lambda x, n, axis: torch.repeat_interleave(x, n, dim=axis))(v_cache[:, :, Sk - W:, :], rep, axis=1)
        scores = torch.einsum("bhqd,bhkd->bhqk", q, k) * (Dh ** -0.5)
        p = _softmax(scores, axis=-1)
        o = torch.einsum("bhqk,bhkd->bhqd", p, v)
        return (lambda x, *d: x.permute(*d))(o, 0, 2, 1, 3).reshape(B, Sq, Hq * Dh) @ wo

    a = _A_ref(A_x, A_k_cache, A_v_cache, A_wq, A_wo)
    b = _B_ref(B_x, B_k_cache, B_v_cache, B_wq, B_wo)
    return torch.concatenate([a, b], axis=-1)
```

```asm
; @launch grid=(256,1,1) block=(256,1,1) lds=32768
.amdgcn_target "amdgcn-amd-amdhsa--gfx950"
.text
.globl concat_heads__gqa_block_cached__sliding_block_cached__decode_kernel
.p2align 8
.type concat_heads__gqa_block_cached__sliding_block_cached__decode_kernel,@function
concat_heads__gqa_block_cached__sliding_block_cached__decode_kernel:
    s_cmp_ge_u32 s2, 256
    s_cbranch_scc1 L_end
    s_load_dwordx2 s[4:5], s[0:1], 0
    s_load_dwordx2 s[6:7], s[0:1], 8
    s_load_dwordx2 s[8:9], s[0:1], 16
    s_load_dwordx2 s[10:11], s[0:1], 24
    s_load_dwordx2 s[12:13], s[0:1], 32
    s_load_dwordx2 s[62:63], s[0:1], 40
    s_load_dwordx2 s[64:65], s[0:1], 48
    s_load_dwordx2 s[66:67], s[0:1], 56
    s_load_dwordx2 s[76:77], s[0:1], 64
    s_load_dwordx2 s[70:71], s[0:1], 72
    s_load_dwordx2 s[72:73], s[0:1], 80
    s_load_dwordx2 s[36:37], s[0:1], 88
    s_load_dwordx2 s[28:29], s[0:1], 96
    v_lshrrev_b32 v1, 6, v0
    v_and_b32 v2, 63, v0
    v_readfirstlane_b32 s14, v1
    s_and_b32 s16, s2, 7
    s_lshr_b32 s17, s2, 3
    s_lshr_b32 s52, s17, 4
    s_lshr_b32 s53, s17, 2
    s_and_b32 s53, s53, 3
    s_and_b32 s54, s17, 3
    s_lshl_b32 s55, s16, 2
    s_add_u32 s55, s55, s53
    s_lshr_b32 s15, s2, 7
    s_lshl_b32 s18, s16, 4
    s_and_b32 s19, s17, 15
    s_or_b32 s18, s18, s19
    s_lshl_b32 s56, s55, 17
    s_lshl_b32 s57, s54, 8
    s_add_u32 s56, s56, s57
    s_add_u32 s57, s56, 4096
    v_and_b32 v3, 15, v2
    v_lshrrev_b32 v4, 4, v2
    v_lshlrev_b32 v5, 8, v3
    v_lshl_add_u32 v5, v4, 4, v5
    v_lshlrev_b32 v6, 10, v4
    v_lshl_add_u32 v6, v3, 4, v6
    s_mov_b32 s44, 0x05040100
    s_mov_b32 s45, 0x07060302
    s_mov_b32 s46, 0x3e0293ee
    s_lshl_b32 s40, s16, 23
    s_lshl_b32 s41, s17, 15
    s_lshl_b32 s42, s14, 13
    s_add_u32 s47, s40, s41
    s_add_u32 s47, s47, s42
    s_add_u32 s47, s47, 0x700000
    s_lshl_b32 s41, s17, 18
    s_lshl_b32 s42, s14, 13
    s_add_u32 s40, s40, s41
    s_add_u32 s40, s40, s42
    v_lshrrev_b32 v8, 4, v0
    v_lshlrev_b32 v8, 13, v8
    v_lshl_add_u32 v8, v3, 4, v8
    v_and_b32 v10, 3, v0
    v_lshrrev_b32 v11, 2, v0
    v_lshlrev_b32 v12, 13, v11
    v_lshl_add_u32 v12, v10, 4, v12
    v_lshlrev_b32 v13, 1, v11
    v_lshlrev_b32 v7, 4, v2
    s_lshl_b32 s41, s18, 6
    s_add_u32 s84, s41, 0x0
    s_add_u32 s85, s41, 0x80000
    s_add_u32 s86, s41, 0x100000
    s_add_u32 s87, s41, 0x180000
    s_add_u32 s88, s41, 0x200000
    s_add_u32 s89, s41, 0x280000
    s_add_u32 s90, s41, 0x300000
    s_add_u32 s91, s41, 0x380000
    v_mov_b32 v88, -1
    v_mov_b32 v89, -1
    v_mov_b32 v90, -1
    v_mov_b32 v91, -1
    s_waitcnt lgkmcnt(0)
    s_mov_b32 s30, 0x400000
    s_mov_b32 s31, 0x00020000
    s_mov_b32 s38, 0x100
    s_mov_b32 s39, 0x00020000
    s_mov_b32 s74, 0x800
    s_mov_b32 s75, 0x00020000
    s_cmp_eq_u32 s52, 0
    s_cselect_b64 s[32:33], s[12:13], s[70:71]
    s_mov_b32 s34, 0x400000
    s_mov_b32 s35, 0x00020000
    s_cmp_eq_u32 s15, 0
    s_cselect_b64 s[80:81], s[10:11], s[76:77]
    s_cselect_b64 s[76:77], s[4:5], s[62:63]
    s_mov_b32 s78, 0x400
    s_mov_b32 s79, 0x00020000
    s_mov_b32 s82, 0x400000
    s_mov_b32 s83, 0x00020000
    s_mov_b64 s[20:21], s[6:7]
    s_mov_b64 s[24:25], s[8:9]
    s_mov_b64 s[68:69], s[66:67]
    s_mov_b32 s22, 0x4000000
    s_mov_b32 s23, 0x00020000
    s_mov_b32 s26, 0x4000000
    s_mov_b32 s27, 0x00020000
    s_mov_b32 s66, 0x4000000
    s_mov_b32 s67, 0x00020000
    s_mov_b32 s70, 0x4000000
    s_mov_b32 s71, 0x00020000
    s_cmp_eq_u32 s14, 0
    s_cbranch_scc1 L_c0
    buffer_load_dwordx4 v[32:35], v12, s[80:83], s84 offen
    buffer_load_dwordx4 v[36:39], v12, s[80:83], s85 offen
    buffer_load_dwordx4 v[40:43], v12, s[80:83], s86 offen
    buffer_load_dwordx4 v[44:47], v12, s[80:83], s87 offen
    buffer_load_dwordx4 v[48:51], v12, s[80:83], s88 offen
    buffer_load_dwordx4 v[52:55], v12, s[80:83], s89 offen
    buffer_load_dwordx4 v[56:59], v12, s[80:83], s90 offen
    buffer_load_dwordx4 v[60:63], v12, s[80:83], s91 offen
    buffer_load_ushort v64, v13, s[76:79], 0 offen offset:0
    buffer_load_ushort v65, v13, s[76:79], 0 offen offset:128
    buffer_load_ushort v66, v13, s[76:79], 0 offen offset:256
    buffer_load_ushort v67, v13, s[76:79], 0 offen offset:384
    buffer_load_ushort v68, v13, s[76:79], 0 offen offset:512
    buffer_load_ushort v69, v13, s[76:79], 0 offen offset:640
    buffer_load_ushort v70, v13, s[76:79], 0 offen offset:768
    buffer_load_ushort v71, v13, s[76:79], 0 offen offset:896
    s_mov_b32 s48, s47
    s_add_u32 s49, s47, 4096
    buffer_load_dwordx4 v[96:99], v5, s[64:67], s48 offen offset:0 nt
    buffer_load_dwordx4 v[100:103], v5, s[64:67], s48 offen offset:64 nt
    buffer_load_dwordx4 v[104:107], v5, s[64:67], s48 offen offset:128 nt
    buffer_load_dwordx4 v[108:111], v5, s[64:67], s48 offen offset:192 nt
    buffer_load_dwordx4 v[112:115], v5, s[64:67], s49 offen offset:0 nt
    buffer_load_dwordx4 v[116:119], v5, s[64:67], s49 offen offset:64 nt
    buffer_load_dwordx4 v[120:123], v5, s[64:67], s49 offen offset:128 nt
    buffer_load_dwordx4 v[124:127], v5, s[64:67], s49 offen offset:192 nt
    s_waitcnt vmcnt(8)
    s_branch L_cd
L_c0:
    s_setprio 3
    s_lshl_b32 s41, s2, 11
    s_add_u32 s41, s41, 0x20000
    s_add_u32 s42, s41, 0x80000
    buffer_store_dwordx4 v[88:91], v7, s[28:31], s41 offen sc1
    buffer_store_dwordx4 v[88:91], v7, s[28:31], s41 offen offset:1024 sc1
    buffer_store_dwordx4 v[88:91], v7, s[28:31], s42 offen sc1
    buffer_store_dwordx4 v[88:91], v7, s[28:31], s42 offen offset:1024 sc1
    s_lshl_b32 s41, s52, 2
    s_add_u32 s41, s41, s54
    s_lshl_b32 s41, s41, 5
    s_add_u32 s41, s41, s55
    s_lshl_b32 s41, s41, 9
    s_add_u32 s41, s41, 0x200000
    v_cmp_gt_u32 vcc, 32, v2
    s_and_saveexec_b64 s[50:51], vcc
    buffer_store_dwordx4 v[88:91], v7, s[28:31], s41 offen sc1
    v_cmp_gt_u32 vcc, 4, v2
    s_and_b64 exec, exec, vcc
    s_lshl_b32 s41, s15, 14
    s_lshl_b32 s42, s18, 7
    s_add_u32 s58, s41, s42
    buffer_store_dwordx4 v[88:91], v7, s[28:31], s58 offen offset:0 sc1
    v_cmp_gt_u32 vcc, 2, v2
    s_and_b64 exec, exec, vcc
    s_lshl_b32 s41, s2, 7
    s_add_u32 s41, s41, 0x10000
    s_add_u32 s42, s41, 0x8000
    buffer_store_dwordx4 v[88:91], v7, s[28:31], s41 offen sc1
    buffer_store_dwordx4 v[88:91], v7, s[28:31], s42 offen sc1
    s_mov_b64 exec, s[50:51]
    buffer_load_dwordx4 v[32:35], v12, s[80:83], s84 offen
    buffer_load_dwordx4 v[36:39], v12, s[80:83], s85 offen
    buffer_load_dwordx4 v[40:43], v12, s[80:83], s86 offen
    buffer_load_dwordx4 v[44:47], v12, s[80:83], s87 offen
    buffer_load_dwordx4 v[48:51], v12, s[80:83], s88 offen
    buffer_load_dwordx4 v[52:55], v12, s[80:83], s89 offen
    buffer_load_dwordx4 v[56:59], v12, s[80:83], s90 offen
    buffer_load_dwordx4 v[60:63], v12, s[80:83], s91 offen
    buffer_load_ushort v64, v13, s[76:79], 0 offen offset:0
    buffer_load_ushort v65, v13, s[76:79], 0 offen offset:128
    buffer_load_ushort v66, v13, s[76:79], 0 offen offset:256
    buffer_load_ushort v67, v13, s[76:79], 0 offen offset:384
    buffer_load_ushort v68, v13, s[76:79], 0 offen offset:512
    buffer_load_ushort v69, v13, s[76:79], 0 offen offset:640
    buffer_load_ushort v70, v13, s[76:79], 0 offen offset:768
    buffer_load_ushort v71, v13, s[76:79], 0 offen offset:896
    s_mov_b32 s48, s47
    s_add_u32 s49, s47, 4096
    buffer_load_dwordx4 v[96:99], v5, s[64:67], s48 offen offset:0 nt
    buffer_load_dwordx4 v[100:103], v5, s[64:67], s48 offen offset:64 nt
    buffer_load_dwordx4 v[104:107], v5, s[64:67], s48 offen offset:128 nt
    buffer_load_dwordx4 v[108:111], v5, s[64:67], s48 offen offset:192 nt
    buffer_load_dwordx4 v[112:115], v5, s[64:67], s49 offen offset:0 nt
    buffer_load_dwordx4 v[116:119], v5, s[64:67], s49 offen offset:64 nt
    buffer_load_dwordx4 v[120:123], v5, s[64:67], s49 offen offset:128 nt
    buffer_load_dwordx4 v[124:127], v5, s[64:67], s49 offen offset:192 nt
    s_mov_b32 s48, s47
    s_add_u32 s49, s47, 4096
    buffer_load_dwordx4 v[128:131], v6, s[68:71], s48 offen offset:0 nt
    buffer_load_dwordx4 v[132:135], v6, s[68:71], s48 offen offset:256 nt
    buffer_load_dwordx4 v[136:139], v6, s[68:71], s48 offen offset:512 nt
    buffer_load_dwordx4 v[140:143], v6, s[68:71], s48 offen offset:768 nt
    buffer_load_dwordx4 v[144:147], v6, s[68:71], s49 offen offset:0 nt
    buffer_load_dwordx4 v[148:151], v6, s[68:71], s49 offen offset:256 nt
    buffer_load_dwordx4 v[152:155], v6, s[68:71], s49 offen offset:512 nt
    buffer_load_dwordx4 v[156:159], v6, s[68:71], s49 offen offset:768 nt
    s_waitcnt vmcnt(32)
    s_and_b32 s41, s2, 1
    s_lshl_b32 s41, s41, 6
    s_movk_i32 s59, 127
    v_cmp_eq_u32 vcc, 0, v2
    s_and_saveexec_b64 s[50:51], vcc
    v_mov_b32 v14, s41
    v_mov_b32 v9, 1
    buffer_atomic_add v9, v14, s[36:39], 0 offen sc0 sc1
    s_mov_b64 exec, s[50:51]
    s_waitcnt vmcnt(17)
L_cd:
    v_mov_b32 v72, 0
    v_mov_b32 v73, 0
    v_mov_b32 v74, 0
    v_mov_b32 v75, 0
    v_mov_b32 v76, 0
    v_mov_b32 v77, 0
    v_mov_b32 v78, 0
    v_mov_b32 v79, 0
    v_lshlrev_b32 v64, 16, v64
    v_lshlrev_b32 v65, 16, v65
    v_lshlrev_b32 v66, 16, v66
    v_lshlrev_b32 v67, 16, v67
    v_lshlrev_b32 v68, 16, v68
    v_lshlrev_b32 v69, 16, v69
    v_lshlrev_b32 v70, 16, v70
    v_lshlrev_b32 v71, 16, v71
    v_lshlrev_b32 v80, 16, v32
    v_and_b32 v81, 0xffff0000, v32
    v_fmac_f32 v72, v64, v80
    v_fmac_f32 v73, v64, v81
    v_lshlrev_b32 v80, 16, v33
    v_and_b32 v81, 0xffff0000, v33
    v_fmac_f32 v74, v64, v80
    v_fmac_f32 v75, v64, v81
    v_lshlrev_b32 v80, 16, v34
    v_and_b32 v81, 0xffff0000, v34
    v_fmac_f32 v76, v64, v80
    v_fmac_f32 v77, v64, v81
    v_lshlrev_b32 v80, 16, v35
    v_and_b32 v81, 0xffff0000, v35
    v_fmac_f32 v78, v64, v80
    v_fmac_f32 v79, v64, v81
    v_lshlrev_b32 v80, 16, v36
    v_and_b32 v81, 0xffff0000, v36
    v_fmac_f32 v72, v65, v80
    v_fmac_f32 v73, v65, v81
    v_lshlrev_b32 v80, 16, v37
    v_and_b32 v81, 0xffff0000, v37
    v_fmac_f32 v74, v65, v80
    v_fmac_f32 v75, v65, v81
    v_lshlrev_b32 v80, 16, v38
    v_and_b32 v81, 0xffff0000, v38
    v_fmac_f32 v76, v65, v80
    v_fmac_f32 v77, v65, v81
    v_lshlrev_b32 v80, 16, v39
    v_and_b32 v81, 0xffff0000, v39
    v_fmac_f32 v78, v65, v80
    v_fmac_f32 v79, v65, v81
    v_lshlrev_b32 v80, 16, v40
    v_and_b32 v81, 0xffff0000, v40
    v_fmac_f32 v72, v66, v80
    v_fmac_f32 v73, v66, v81
    v_lshlrev_b32 v80, 16, v41
    v_and_b32 v81, 0xffff0000, v41
    v_fmac_f32 v74, v66, v80
    v_fmac_f32 v75, v66, v81
    v_lshlrev_b32 v80, 16, v42
    v_and_b32 v81, 0xffff0000, v42
    v_fmac_f32 v76, v66, v80
    v_fmac_f32 v77, v66, v81
    v_lshlrev_b32 v80, 16, v43
    v_and_b32 v81, 0xffff0000, v43
    v_fmac_f32 v78, v66, v80
    v_fmac_f32 v79, v66, v81
    v_lshlrev_b32 v80, 16, v44
    v_and_b32 v81, 0xffff0000, v44
    v_fmac_f32 v72, v67, v80
    v_fmac_f32 v73, v67, v81
    v_lshlrev_b32 v80, 16, v45
    v_and_b32 v81, 0xffff0000, v45
    v_fmac_f32 v74, v67, v80
    v_fmac_f32 v75, v67, v81
    v_lshlrev_b32 v80, 16, v46
    v_and_b32 v81, 0xffff0000, v46
    v_fmac_f32 v76, v67, v80
    v_fmac_f32 v77, v67, v81
    v_lshlrev_b32 v80, 16, v47
    v_and_b32 v81, 0xffff0000, v47
    v_fmac_f32 v78, v67, v80
    v_fmac_f32 v79, v67, v81
    v_lshlrev_b32 v80, 16, v48
    v_and_b32 v81, 0xffff0000, v48
    v_fmac_f32 v72, v68, v80
    v_fmac_f32 v73, v68, v81
    v_lshlrev_b32 v80, 16, v49
    v_and_b32 v81, 0xffff0000, v49
    v_fmac_f32 v74, v68, v80
    v_fmac_f32 v75, v68, v81
    v_lshlrev_b32 v80, 16, v50
    v_and_b32 v81, 0xffff0000, v50
    v_fmac_f32 v76, v68, v80
    v_fmac_f32 v77, v68, v81
    v_lshlrev_b32 v80, 16, v51
    v_and_b32 v81, 0xffff0000, v51
    v_fmac_f32 v78, v68, v80
    v_fmac_f32 v79, v68, v81
    v_lshlrev_b32 v80, 16, v52
    v_and_b32 v81, 0xffff0000, v52
    v_fmac_f32 v72, v69, v80
    v_fmac_f32 v73, v69, v81
    v_lshlrev_b32 v80, 16, v53
    v_and_b32 v81, 0xffff0000, v53
    v_fmac_f32 v74, v69, v80
    v_fmac_f32 v75, v69, v81
    v_lshlrev_b32 v80, 16, v54
    v_and_b32 v81, 0xffff0000, v54
    v_fmac_f32 v76, v69, v80
    v_fmac_f32 v77, v69, v81
    v_lshlrev_b32 v80, 16, v55
    v_and_b32 v81, 0xffff0000, v55
    v_fmac_f32 v78, v69, v80
    v_fmac_f32 v79, v69, v81
    v_lshlrev_b32 v80, 16, v56
    v_and_b32 v81, 0xffff0000, v56
    v_fmac_f32 v72, v70, v80
    v_fmac_f32 v73, v70, v81
    v_lshlrev_b32 v80, 16, v57
    v_and_b32 v81, 0xffff0000, v57
    v_fmac_f32 v74, v70, v80
    v_fmac_f32 v75, v70, v81
    v_lshlrev_b32 v80, 16, v58
    v_and_b32 v81, 0xffff0000, v58
    v_fmac_f32 v76, v70, v80
    v_fmac_f32 v77, v70, v81
    v_lshlrev_b32 v80, 16, v59
    v_and_b32 v81, 0xffff0000, v59
    v_fmac_f32 v78, v70, v80
    v_fmac_f32 v79, v70, v81
    v_lshlrev_b32 v80, 16, v60
    v_and_b32 v81, 0xffff0000, v60
    v_fmac_f32 v72, v71, v80
    v_fmac_f32 v73, v71, v81
    v_lshlrev_b32 v80, 16, v61
    v_and_b32 v81, 0xffff0000, v61
    v_fmac_f32 v74, v71, v80
    v_fmac_f32 v75, v71, v81
    v_lshlrev_b32 v80, 16, v62
    v_and_b32 v81, 0xffff0000, v62
    v_fmac_f32 v76, v71, v80
    v_fmac_f32 v77, v71, v81
    v_lshlrev_b32 v80, 16, v63
    v_and_b32 v81, 0xffff0000, v63
    v_fmac_f32 v78, v71, v80
    v_fmac_f32 v79, v71, v81
    s_nop 1
    v_add_f32_dpp v80, v72, v72 row_ror:4 row_mask:0xf bank_mask:0xf
    v_add_f32_dpp v81, v73, v73 row_ror:4 row_mask:0xf bank_mask:0xf
    v_add_f32_dpp v82, v74, v74 row_ror:4 row_mask:0xf bank_mask:0xf
    v_add_f32_dpp v83, v75, v75 row_ror:4 row_mask:0xf bank_mask:0xf
    v_add_f32_dpp v84, v76, v76 row_ror:4 row_mask:0xf bank_mask:0xf
    v_add_f32_dpp v85, v77, v77 row_ror:4 row_mask:0xf bank_mask:0xf
    v_add_f32_dpp v86, v78, v78 row_ror:4 row_mask:0xf bank_mask:0xf
    v_add_f32_dpp v87, v79, v79 row_ror:4 row_mask:0xf bank_mask:0xf
    s_nop 1
    v_add_f32_dpp v72, v80, v80 row_ror:8 row_mask:0xf bank_mask:0xf
    v_add_f32_dpp v73, v81, v81 row_ror:8 row_mask:0xf bank_mask:0xf
    v_add_f32_dpp v74, v82, v82 row_ror:8 row_mask:0xf bank_mask:0xf
    v_add_f32_dpp v75, v83, v83 row_ror:8 row_mask:0xf bank_mask:0xf
    v_add_f32_dpp v76, v84, v84 row_ror:8 row_mask:0xf bank_mask:0xf
    v_add_f32_dpp v77, v85, v85 row_ror:8 row_mask:0xf bank_mask:0xf
    v_add_f32_dpp v78, v86, v86 row_ror:8 row_mask:0xf bank_mask:0xf
    v_add_f32_dpp v79, v87, v87 row_ror:8 row_mask:0xf bank_mask:0xf
    v_lshrrev_b32 v14, 4, v0
    v_lshlrev_b32 v14, 7, v14
    v_lshl_add_u32 v14, v10, 5, v14
    v_cmp_gt_u32 vcc, 4, v3
    s_and_saveexec_b64 s[50:51], vcc
    ds_write_b128 v14, v[72:75] offset:28672
    ds_write_b128 v14, v[76:79] offset:28688
    s_mov_b64 exec, s[50:51]
    s_waitcnt lgkmcnt(0)
    s_barrier
    s_cmp_eq_u32 s14, 0
    s_cbranch_scc1 L_helper
    s_waitcnt vmcnt(0)
    s_mov_b32 s48, s47
    s_add_u32 s49, s47, 4096
    buffer_load_dwordx4 v[128:131], v6, s[68:71], s48 offen offset:0 nt
    buffer_load_dwordx4 v[132:135], v6, s[68:71], s48 offen offset:256 nt
    buffer_load_dwordx4 v[136:139], v6, s[68:71], s48 offen offset:512 nt
    buffer_load_dwordx4 v[140:143], v6, s[68:71], s48 offen offset:768 nt
    buffer_load_dwordx4 v[144:147], v6, s[68:71], s49 offen offset:0 nt
    buffer_load_dwordx4 v[148:151], v6, s[68:71], s49 offen offset:256 nt
    buffer_load_dwordx4 v[152:155], v6, s[68:71], s49 offen offset:512 nt
    buffer_load_dwordx4 v[156:159], v6, s[68:71], s49 offen offset:768 nt
    s_waitcnt vmcnt(0)
    s_add_u32 s48, s40, 0x0
    s_add_u32 s49, s40, 0x1000
    buffer_load_dwordx4 v[160:163], v5, s[20:23], s48 offen offset:0 nt
    buffer_load_dwordx4 v[164:167], v5, s[20:23], s48 offen offset:64 nt
    buffer_load_dwordx4 v[168:171], v5, s[20:23], s48 offen offset:128 nt
    buffer_load_dwordx4 v[172:175], v5, s[20:23], s48 offen offset:192 nt
    buffer_load_dwordx4 v[176:179], v5, s[20:23], s49 offen offset:0 nt
    buffer_load_dwordx4 v[180:183], v5, s[20:23], s49 offen offset:64 nt
    buffer_load_dwordx4 v[184:187], v5, s[20:23], s49 offen offset:128 nt
    buffer_load_dwordx4 v[188:191], v5, s[20:23], s49 offen offset:192 nt
    s_waitcnt vmcnt(0)
    s_add_u32 s48, s40, 0x0
    s_add_u32 s49, s40, 0x1000
    buffer_load_dwordx4 v[192:195], v6, s[24:27], s48 offen offset:0 nt
    buffer_load_dwordx4 v[196:199], v6, s[24:27], s48 offen offset:256 nt
    buffer_load_dwordx4 v[200:203], v6, s[24:27], s48 offen offset:512 nt
    buffer_load_dwordx4 v[204:207], v6, s[24:27], s48 offen offset:768 nt
    buffer_load_dwordx4 v[208:211], v6, s[24:27], s49 offen offset:0 nt
    buffer_load_dwordx4 v[212:215], v6, s[24:27], s49 offen offset:256 nt
    buffer_load_dwordx4 v[216:219], v6, s[24:27], s49 offen offset:512 nt
    buffer_load_dwordx4 v[220:223], v6, s[24:27], s49 offen offset:768 nt
    s_waitcnt vmcnt(0)
    s_add_u32 s48, s40, 0x8000
    s_add_u32 s49, s40, 0x9000
    buffer_load_dwordx4 v[224:227], v5, s[20:23], s48 offen offset:0 nt
    buffer_load_dwordx4 v[228:231], v5, s[20:23], s48 offen offset:64 nt
    buffer_load_dwordx4 v[232:235], v5, s[20:23], s48 offen offset:128 nt
    buffer_load_dwordx4 v[236:239], v5, s[20:23], s48 offen offset:192 nt
    buffer_load_dwordx4 v[240:243], v5, s[20:23], s49 offen offset:0 nt
    buffer_load_dwordx4 v[244:247], v5, s[20:23], s49 offen offset:64 nt
    buffer_load_dwordx4 v[248:251], v5, s[20:23], s49 offen offset:128 nt
    buffer_load_dwordx4 v[252:255], v5, s[20:23], s49 offen offset:192 nt
    s_barrier
    s_branch L_go
L_helper:
    v_cmp_gt_u32 vcc, 32, v2
    s_and_saveexec_b64 s[50:51], vcc
    v_lshlrev_b32 v14, 2, v2
    ds_read_b32 v32, v14 offset:28672
    ds_read_b32 v33, v14 offset:28800
    ds_read_b32 v34, v14 offset:28928
    ds_read_b32 v35, v14 offset:29056
    ds_read_b32 v36, v14 offset:29184
    ds_read_b32 v37, v14 offset:29312
    ds_read_b32 v38, v14 offset:29440
    ds_read_b32 v39, v14 offset:29568
    ds_read_b32 v40, v14 offset:29696
    ds_read_b32 v41, v14 offset:29824
    ds_read_b32 v42, v14 offset:29952
    ds_read_b32 v43, v14 offset:30080
    ds_read_b32 v44, v14 offset:30208
    ds_read_b32 v45, v14 offset:30336
    ds_read_b32 v46, v14 offset:30464
    ds_read_b32 v47, v14 offset:30592
    s_waitcnt lgkmcnt(0)
    v_add_f32 v32, v32, v33
    v_add_f32 v32, v32, v34
    v_add_f32 v32, v32, v35
    v_add_f32 v32, v32, v36
    v_add_f32 v32, v32, v37
    v_add_f32 v32, v32, v38
    v_add_f32 v32, v32, v39
    v_add_f32 v32, v32, v40
    v_add_f32 v32, v32, v41
    v_add_f32 v32, v32, v42
    v_add_f32 v32, v32, v43
    v_add_f32 v32, v32, v44
    v_add_f32 v32, v32, v45
    v_add_f32 v32, v32, v46
    v_add_f32 v32, v32, v47
    s_nop 1
    v_mov_b32_dpp v33, v32 quad_perm:[1,0,3,2] row_mask:0xf bank_mask:0xf
    s_nop 0
    v_cvt_pk_bf16_f32 v32, v32, v33
    v_and_b32 v14, 1, v2
    v_cmp_eq_u32 vcc, 0, v14
    s_and_b64 exec, exec, vcc
    v_lshlrev_b32 v14, 1, v2
    buffer_store_dword v32, v14, s[28:31], s58 offen offset:0 sc1
    s_mov_b64 exec, s[50:51]
    s_waitcnt vmcnt(1)
    v_readfirstlane_b32 s43, v9
    s_cmp_lg_u32 s43, s59
    s_cbranch_scc1 L_notlast
    v_cmp_eq_u32 vcc, 0, v2
    s_and_saveexec_b64 s[50:51], vcc
    v_mov_b32 v14, 192
    v_mov_b32 v15, 1
    buffer_atomic_add v15, v14, s[36:39], 0 offen sc1
    s_mov_b64 exec, s[50:51]
L_notlast:
    s_mov_b32 s60, 0
    v_mov_b32 v14, 192
L_pq:
    buffer_load_dword v15, v14, s[36:39], 0 offen sc1
    s_waitcnt vmcnt(0)
    v_cmp_gt_u32 vcc, 2, v15
    s_cbranch_vccz L_pq_done
    s_add_u32 s60, s60, 1
    s_cmp_lt_u32 s60, 0x40000
    s_cbranch_scc0 L_pq_done
    s_sleep 4
    s_branch L_pq
L_pq_done:
    v_lshrrev_b32 v14, 2, v2
    v_lshlrev_b32 v14, 7, v14
    v_and_b32 v15, 3, v2
    v_lshl_add_u32 v14, v15, 4, v14
    s_lshl_b32 s41, s16, 11
    s_add_u32 s42, s41, 16384
L_pqd:
    buffer_load_dwordx4 v[64:67], v14, s[28:31], s41 offen offset:0 sc1
    buffer_load_dwordx4 v[68:71], v14, s[28:31], s42 offen offset:0 sc1
    s_waitcnt vmcnt(0)
    v_max3_u32 v15, v64, v65, v66
    v_max3_u32 v15, v15, v67, v68
    v_max3_u32 v15, v15, v69, v70
    v_max_u32 v15, v15, v71
    v_cmp_eq_u32 vcc, -1, v15
    s_cbranch_vccz L_pqd_done
    s_add_u32 s60, s60, 1
    s_cmp_lt_u32 s60, 0x40000
    s_cbranch_scc0 L_pqd_done
    s_sleep 1
    s_branch L_pqd
L_pqd_done:
    ds_write_b128 v7, v[64:67] offset:30720
    ds_write_b128 v7, v[68:71] offset:31744
    s_waitcnt lgkmcnt(0)
    s_setprio 0
    s_barrier
    s_add_u32 s48, s40, 0x0
    s_add_u32 s49, s40, 0x1000
    buffer_load_dwordx4 v[160:163], v5, s[20:23], s48 offen offset:0 nt
    buffer_load_dwordx4 v[164:167], v5, s[20:23], s48 offen offset:64 nt
    buffer_load_dwordx4 v[168:171], v5, s[20:23], s48 offen offset:128 nt
    buffer_load_dwordx4 v[172:175], v5, s[20:23], s48 offen offset:192 nt
    buffer_load_dwordx4 v[176:179], v5, s[20:23], s49 offen offset:0 nt
    buffer_load_dwordx4 v[180:183], v5, s[20:23], s49 offen offset:64 nt
    buffer_load_dwordx4 v[184:187], v5, s[20:23], s49 offen offset:128 nt
    buffer_load_dwordx4 v[188:191], v5, s[20:23], s49 offen offset:192 nt
    s_add_u32 s48, s40, 0x0
    s_add_u32 s49, s40, 0x1000
    buffer_load_dwordx4 v[192:195], v6, s[24:27], s48 offen offset:0 nt
    buffer_load_dwordx4 v[196:199], v6, s[24:27], s48 offen offset:256 nt
    buffer_load_dwordx4 v[200:203], v6, s[24:27], s48 offen offset:512 nt
    buffer_load_dwordx4 v[204:207], v6, s[24:27], s48 offen offset:768 nt
    buffer_load_dwordx4 v[208:211], v6, s[24:27], s49 offen offset:0 nt
    buffer_load_dwordx4 v[212:215], v6, s[24:27], s49 offen offset:256 nt
    buffer_load_dwordx4 v[216:219], v6, s[24:27], s49 offen offset:512 nt
    buffer_load_dwordx4 v[220:223], v6, s[24:27], s49 offen offset:768 nt
    s_add_u32 s48, s40, 0x8000
    s_add_u32 s49, s40, 0x9000
    buffer_load_dwordx4 v[224:227], v5, s[20:23], s48 offen offset:0 nt
    buffer_load_dwordx4 v[228:231], v5, s[20:23], s48 offen offset:64 nt
    buffer_load_dwordx4 v[232:235], v5, s[20:23], s48 offen offset:128 nt
    buffer_load_dwordx4 v[236:239], v5, s[20:23], s48 offen offset:192 nt
    buffer_load_dwordx4 v[240:243], v5, s[20:23], s49 offen offset:0 nt
    buffer_load_dwordx4 v[244:247], v5, s[20:23], s49 offen offset:64 nt
    buffer_load_dwordx4 v[248:251], v5, s[20:23], s49 offen offset:128 nt
    buffer_load_dwordx4 v[252:255], v5, s[20:23], s49 offen offset:192 nt
L_go:
    v_mov_b32 v16, 0
    v_mov_b32 v76, 0
    v_mov_b32 v17, 0
    v_mov_b32 v77, 0
    v_mov_b32 v18, 0
    v_mov_b32 v78, 0
    v_mov_b32 v19, 0
    v_mov_b32 v79, 0
    v_mov_b32 v20, 0
    v_mov_b32 v80, 0
    v_mov_b32 v21, 0
    v_mov_b32 v81, 0
    v_mov_b32 v22, 0
    v_mov_b32 v82, 0
    v_mov_b32 v23, 0
    v_mov_b32 v83, 0
    v_mov_b32 v24, 0
    v_mov_b32 v84, 0
    v_mov_b32 v25, 0
    v_mov_b32 v85, 0
    v_mov_b32 v26, 0
    v_mov_b32 v86, 0
    v_mov_b32 v27, 0
    v_mov_b32 v87, 0
    v_mov_b32 v28, 0
    v_mov_b32 v88, 0
    v_mov_b32 v29, 0
    v_mov_b32 v89, 0
    v_mov_b32 v30, 0
    v_mov_b32 v90, 0
    v_mov_b32 v31, 0
    v_mov_b32 v91, 0
    v_cmp_gt_u32 vcc, 4, v3
    s_and_saveexec_b64 s[50:51], vcc
    ds_read_b128 v[16:19], v5 offset:30720
    ds_read_b128 v[76:79], v5 offset:31744
    ds_read_b128 v[20:23], v5 offset:30784
    ds_read_b128 v[80:83], v5 offset:31808
    ds_read_b128 v[24:27], v5 offset:30848
    ds_read_b128 v[84:87], v5 offset:31872
    ds_read_b128 v[28:31], v5 offset:30912
    ds_read_b128 v[88:91], v5 offset:31936
    s_mov_b64 exec, s[50:51]
    v_mov_b32 v32, 0
    v_mov_b32 v33, 0
    v_mov_b32 v34, 0
    v_mov_b32 v35, 0
    v_mov_b32 v36, 0
    v_mov_b32 v37, 0
    v_mov_b32 v38, 0
    v_mov_b32 v39, 0
    v_mov_b32 v40, 0
    v_mov_b32 v41, 0
    v_mov_b32 v42, 0
    v_mov_b32 v43, 0
    v_mov_b32 v44, 0
    v_mov_b32 v45, 0
    v_mov_b32 v46, 0
    v_mov_b32 v47, 0
    v_mov_b32 v48, 0
    v_mov_b32 v49, 0
    v_mov_b32 v50, 0
    v_mov_b32 v51, 0
    v_mov_b32 v52, 0
    v_mov_b32 v53, 0
    v_mov_b32 v54, 0
    v_mov_b32 v55, 0
    v_mov_b32 v56, 0
    v_mov_b32 v57, 0
    v_mov_b32 v58, 0
    v_mov_b32 v59, 0
    v_mov_b32 v60, 0
    v_mov_b32 v61, 0
    v_mov_b32 v62, 0
    v_mov_b32 v63, 0
    v_mov_b32 v9, 0xf149f2ca
    v_mov_b32 v10, 0
    s_waitcnt lgkmcnt(0)
    s_waitcnt vmcnt(32)
    v_mfma_f32_16x16x32_bf16 v[64:67], v[96:99], v[76:79], 0
    v_mfma_f32_16x16x32_bf16 v[68:71], v[112:115], v[76:79], 0
    v_mfma_f32_16x16x32_bf16 v[64:67], v[100:103], v[80:83], v[64:67]
    v_mfma_f32_16x16x32_bf16 v[68:71], v[116:119], v[80:83], v[68:71]
    v_mfma_f32_16x16x32_bf16 v[64:67], v[104:107], v[84:87], v[64:67]
    v_mfma_f32_16x16x32_bf16 v[68:71], v[120:123], v[84:87], v[68:71]
    v_mfma_f32_16x16x32_bf16 v[64:67], v[108:111], v[88:91], v[64:67]
    v_mfma_f32_16x16x32_bf16 v[68:71], v[124:127], v[88:91], v[68:71]
    s_add_u32 s48, s40, 0x8000
    s_add_u32 s49, s40, 0x9000
    buffer_load_dwordx4 v[96:99], v6, s[24:27], s48 offen offset:0 nt
    buffer_load_dwordx4 v[100:103], v6, s[24:27], s48 offen offset:256 nt
    buffer_load_dwordx4 v[104:107], v6, s[24:27], s48 offen offset:512 nt
    buffer_load_dwordx4 v[108:111], v6, s[24:27], s48 offen offset:768 nt
    buffer_load_dwordx4 v[112:115], v6, s[24:27], s49 offen offset:0 nt
    buffer_load_dwordx4 v[116:119], v6, s[24:27], s49 offen offset:256 nt
    buffer_load_dwordx4 v[120:123], v6, s[24:27], s49 offen offset:512 nt
    buffer_load_dwordx4 v[124:127], v6, s[24:27], s49 offen offset:768 nt
    v_max3_f32 v12, v64, v65, v66
    v_max3_f32 v14, v67, v68, v69
    v_max3_f32 v12, v12, v70, v71
    v_max_f32 v12, v12, v14
    v_mov_b32 v13, v12
    s_nop 1
    v_permlane32_swap_b32 v12, v13
    v_max_f32 v12, v12, v13
    v_mov_b32 v13, v12
    s_nop 1
    v_permlane16_swap_b32 v12, v13
    v_max3_f32 v12, v12, v13, v9
    v_cmp_gt_f32 vcc, v12, v9
    s_cbranch_vccz L_nors_a_0
    v_sub_f32 v15, v9, v12
    v_mul_f32 v15, s46, v15
    v_exp_f32 v15, v15
    s_nop 0
    v_mul_f32 v10, v10, v15
    v_mul_f32 v32, v32, v15
    v_mul_f32 v33, v33, v15
    v_mul_f32 v34, v34, v15
    v_mul_f32 v35, v35, v15
    v_mul_f32 v36, v36, v15
    v_mul_f32 v37, v37, v15
    v_mul_f32 v38, v38, v15
    v_mul_f32 v39, v39, v15
    v_mul_f32 v40, v40, v15
    v_mul_f32 v41, v41, v15
    v_mul_f32 v42, v42, v15
    v_mul_f32 v43, v43, v15
    v_mul_f32 v44, v44, v15
    v_mul_f32 v45, v45, v15
    v_mul_f32 v46, v46, v15
    v_mul_f32 v47, v47, v15
    v_mul_f32 v48, v48, v15
    v_mul_f32 v49, v49, v15
    v_mul_f32 v50, v50, v15
    v_mul_f32 v51, v51, v15
    v_mul_f32 v52, v52, v15
    v_mul_f32 v53, v53, v15
    v_mul_f32 v54, v54, v15
    v_mul_f32 v55, v55, v15
    v_mul_f32 v56, v56, v15
    v_mul_f32 v57, v57, v15
    v_mul_f32 v58, v58, v15
    v_mul_f32 v59, v59, v15
    v_mul_f32 v60, v60, v15
    v_mul_f32 v61, v61, v15
    v_mul_f32 v62, v62, v15
    v_mul_f32 v63, v63, v15
L_nors_a_0:
    v_mov_b32 v9, v12
    v_mul_f32 v11, s46, v12
    v_fma_f32 v64, v64, s46, -v11
    v_fma_f32 v65, v65, s46, -v11
    v_fma_f32 v66, v66, s46, -v11
    v_fma_f32 v67, v67, s46, -v11
    v_fma_f32 v68, v68, s46, -v11
    v_fma_f32 v69, v69, s46, -v11
    v_fma_f32 v70, v70, s46, -v11
    v_fma_f32 v71, v71, s46, -v11
    v_exp_f32 v64, v64
    v_exp_f32 v65, v65
    v_exp_f32 v66, v66
    v_exp_f32 v67, v67
    v_exp_f32 v68, v68
    v_exp_f32 v69, v69
    v_exp_f32 v70, v70
    v_exp_f32 v71, v71
    s_nop 0
    v_cvt_pk_bf16_f32 v72, v64, v65
    v_cvt_pk_bf16_f32 v73, v66, v67
    v_cvt_pk_bf16_f32 v74, v68, v69
    v_cvt_pk_bf16_f32 v75, v70, v71
    v_add_f32 v10, v10, v64
    v_add_f32 v10, v10, v65
    v_add_f32 v10, v10, v66
    v_add_f32 v10, v10, v67
    v_add_f32 v10, v10, v68
    v_add_f32 v10, v10, v69
    v_add_f32 v10, v10, v70
    v_add_f32 v10, v10, v71
    s_waitcnt vmcnt(32)
    v_perm_b32 v76, v132, v128, s44
    v_perm_b32 v77, v140, v136, s44
    v_perm_b32 v78, v148, v144, s44
    v_perm_b32 v79, v156, v152, s44
    v_perm_b32 v80, v132, v128, s45
    v_perm_b32 v81, v140, v136, s45
    v_perm_b32 v82, v148, v144, s45
    v_perm_b32 v83, v156, v152, s45
    v_perm_b32 v84, v133, v129, s44
    v_perm_b32 v85, v141, v137, s44
    v_perm_b32 v86, v149, v145, s44
    v_perm_b32 v87, v157, v153, s44
    v_perm_b32 v88, v133, v129, s45
    v_perm_b32 v89, v141, v137, s45
    v_perm_b32 v90, v149, v145, s45
    v_perm_b32 v91, v157, v153, s45
    v_mfma_f32_16x16x32_bf16 v[32:35], v[76:79], v[72:75], v[32:35]
    v_mfma_f32_16x16x32_bf16 v[36:39], v[80:83], v[72:75], v[36:39]
    v_perm_b32 v76, v134, v130, s44
    v_perm_b32 v77, v142, v138, s44
    v_perm_b32 v78, v150, v146, s44
    v_perm_b32 v79, v158, v154, s44
    v_perm_b32 v80, v134, v130, s45
    v_perm_b32 v81, v142, v138, s45
    v_perm_b32 v82, v150, v146, s45
    v_perm_b32 v83, v158, v154, s45
    v_mfma_f32_16x16x32_bf16 v[40:43], v[84:87], v[72:75], v[40:43]
    v_mfma_f32_16x16x32_bf16 v[44:47], v[88:91], v[72:75], v[44:47]
    v_perm_b32 v84, v135, v131, s44
    v_perm_b32 v85, v143, v139, s44
    v_perm_b32 v86, v151, v147, s44
    v_perm_b32 v87, v159, v155, s44
    v_perm_b32 v88, v135, v131, s45
    v_perm_b32 v89, v143, v139, s45
    v_perm_b32 v90, v151, v147, s45
    v_perm_b32 v91, v159, v155, s45
    s_add_u32 s48, s40, 0x10000
    s_add_u32 s49, s40, 0x11000
    buffer_load_dwordx4 v[128:131], v5, s[20:23], s48 offen offset:0 nt
    buffer_load_dwordx4 v[132:135], v5, s[20:23], s48 offen offset:64 nt
    buffer_load_dwordx4 v[136:139], v5, s[20:23], s48 offen offset:128 nt
    buffer_load_dwordx4 v[140:143], v5, s[20:23], s48 offen offset:192 nt
    buffer_load_dwordx4 v[144:147], v5, s[20:23], s49 offen offset:0 nt
    buffer_load_dwordx4 v[148:151], v5, s[20:23], s49 offen offset:64 nt
    buffer_load_dwordx4 v[152:155], v5, s[20:23], s49 offen offset:128 nt
    buffer_load_dwordx4 v[156:159], v5, s[20:23], s49 offen offset:192 nt
    v_mfma_f32_16x16x32_bf16 v[48:51], v[76:79], v[72:75], v[48:51]
    v_mfma_f32_16x16x32_bf16 v[52:55], v[80:83], v[72:75], v[52:55]
    s_nop 1
    v_mfma_f32_16x16x32_bf16 v[56:59], v[84:87], v[72:75], v[56:59]
    v_mfma_f32_16x16x32_bf16 v[60:63], v[88:91], v[72:75], v[60:63]
    v_mov_b32 v13, v10
    s_nop 1
    v_permlane32_swap_b32 v10, v13
    v_add_f32 v10, v10, v13
    v_mov_b32 v13, v10
    s_nop 1
    v_permlane16_swap_b32 v10, v13
    v_add_f32 v10, v10, v13
    v_mov_b32 v12, v9
    v_mov_b32 v13, v10
    s_lshl_b32 s41, s14, 11
    v_lshlrev_b32 v7, 6, v4
    v_lshl_add_u32 v7, v3, 4, v7
    v_add_u32 v7, s41, v7
    s_lshl_b32 s41, s14, 5
    v_lshlrev_b32 v14, 3, v3
    v_add_u32 v14, s41, v14
    v_cmp_gt_u32 vcc, 4, v3
    s_and_saveexec_b64 s[50:51], vcc
    ds_write_b128 v7, v[32:35] offset:8192
    ds_write_b128 v7, v[36:39] offset:8448
    ds_write_b128 v7, v[40:43] offset:8704
    ds_write_b128 v7, v[44:47] offset:8960
    ds_write_b128 v7, v[48:51] offset:9216
    ds_write_b128 v7, v[52:55] offset:9472
    ds_write_b128 v7, v[56:59] offset:9728
    ds_write_b128 v7, v[60:63] offset:9984
    ds_write_b64 v14, v[12:13] offset:16512
    s_mov_b64 exec, s[50:51]
    s_waitcnt lgkmcnt(0)
    v_mov_b32 v32, 0
    v_mov_b32 v33, 0
    v_mov_b32 v34, 0
    v_mov_b32 v35, 0
    v_mov_b32 v36, 0
    v_mov_b32 v37, 0
    v_mov_b32 v38, 0
    v_mov_b32 v39, 0
    v_mov_b32 v40, 0
    v_mov_b32 v41, 0
    v_mov_b32 v42, 0
    v_mov_b32 v43, 0
    v_mov_b32 v44, 0
    v_mov_b32 v45, 0
    v_mov_b32 v46, 0
    v_mov_b32 v47, 0
    v_mov_b32 v48, 0
    v_mov_b32 v49, 0
    v_mov_b32 v50, 0
    v_mov_b32 v51, 0
    v_mov_b32 v52, 0
    v_mov_b32 v53, 0
    v_mov_b32 v54, 0
    v_mov_b32 v55, 0
    v_mov_b32 v56, 0
    v_mov_b32 v57, 0
    v_mov_b32 v58, 0
    v_mov_b32 v59, 0
    v_mov_b32 v60, 0
    v_mov_b32 v61, 0
    v_mov_b32 v62, 0
    v_mov_b32 v63, 0
    v_mov_b32 v9, 0xf149f2ca
    v_mov_b32 v10, 0
    s_waitcnt vmcnt(32)
    v_mfma_f32_16x16x32_bf16 v[64:67], v[160:163], v[16:19], 0
    v_mfma_f32_16x16x32_bf16 v[68:71], v[176:179], v[16:19], 0
    v_mfma_f32_16x16x32_bf16 v[64:67], v[164:167], v[20:23], v[64:67]
    v_mfma_f32_16x16x32_bf16 v[68:71], v[180:183], v[20:23], v[68:71]
    v_mfma_f32_16x16x32_bf16 v[64:67], v[168:171], v[24:27], v[64:67]
    v_mfma_f32_16x16x32_bf16 v[68:71], v[184:187], v[24:27], v[68:71]
    v_mfma_f32_16x16x32_bf16 v[64:67], v[172:175], v[28:31], v[64:67]
    v_mfma_f32_16x16x32_bf16 v[68:71], v[188:191], v[28:31], v[68:71]
    s_add_u32 s48, s40, 0x10000
    s_add_u32 s49, s40, 0x11000
    buffer_load_dwordx4 v[160:163], v6, s[24:27], s48 offen offset:0 nt
    buffer_load_dwordx4 v[164:167], v6, s[24:27], s48 offen offset:256 nt
    buffer_load_dwordx4 v[168:171], v6, s[24:27], s48 offen offset:512 nt
    buffer_load_dwordx4 v[172:175], v6, s[24:27], s48 offen offset:768 nt
    buffer_load_dwordx4 v[176:179], v6, s[24:27], s49 offen offset:0 nt
    buffer_load_dwordx4 v[180:183], v6, s[24:27], s49 offen offset:256 nt
    buffer_load_dwordx4 v[184:187], v6, s[24:27], s49 offen offset:512 nt
    buffer_load_dwordx4 v[188:191], v6, s[24:27], s49 offen offset:768 nt
    v_max3_f32 v12, v64, v65, v66
    v_max3_f32 v14, v67, v68, v69
    v_max3_f32 v12, v12, v70, v71
    v_max_f32 v12, v12, v14
    v_mov_b32 v13, v12
    s_nop 1
    v_permlane32_swap_b32 v12, v13
    v_max_f32 v12, v12, v13
    v_mov_b32 v13, v12
    s_nop 1
    v_permlane16_swap_b32 v12, v13
    v_max3_f32 v12, v12, v13, v9
    v_cmp_gt_f32 vcc, v12, v9
    s_cbranch_vccz L_nors_a_1
    v_sub_f32 v15, v9, v12
    v_mul_f32 v15, s46, v15
    v_exp_f32 v15, v15
    s_nop 0
    v_mul_f32 v10, v10, v15
    v_mul_f32 v32, v32, v15
    v_mul_f32 v33, v33, v15
    v_mul_f32 v34, v34, v15
    v_mul_f32 v35, v35, v15
    v_mul_f32 v36, v36, v15
    v_mul_f32 v37, v37, v15
    v_mul_f32 v38, v38, v15
    v_mul_f32 v39, v39, v15
    v_mul_f32 v40, v40, v15
    v_mul_f32 v41, v41, v15
    v_mul_f32 v42, v42, v15
    v_mul_f32 v43, v43, v15
    v_mul_f32 v44, v44, v15
    v_mul_f32 v45, v45, v15
    v_mul_f32 v46, v46, v15
    v_mul_f32 v47, v47, v15
    v_mul_f32 v48, v48, v15
    v_mul_f32 v49, v49, v15
    v_mul_f32 v50, v50, v15
    v_mul_f32 v51, v51, v15
    v_mul_f32 v52, v52, v15
    v_mul_f32 v53, v53, v15
    v_mul_f32 v54, v54, v15
    v_mul_f32 v55, v55, v15
    v_mul_f32 v56, v56, v15
    v_mul_f32 v57, v57, v15
    v_mul_f32 v58, v58, v15
    v_mul_f32 v59, v59, v15
    v_mul_f32 v60, v60, v15
    v_mul_f32 v61, v61, v15
    v_mul_f32 v62, v62, v15
    v_mul_f32 v63, v63, v15
L_nors_a_1:
    v_mov_b32 v9, v12
    v_mul_f32 v11, s46, v12
    v_fma_f32 v64, v64, s46, -v11
    v_fma_f32 v65, v65, s46, -v11
    v_fma_f32 v66, v66, s46, -v11
    v_fma_f32 v67, v67, s46, -v11
    v_fma_f32 v68, v68, s46, -v11
    v_fma_f32 v69, v69, s46, -v11
    v_fma_f32 v70, v70, s46, -v11
    v_fma_f32 v71, v71, s46, -v11
    v_exp_f32 v64, v64
    v_exp_f32 v65, v65
    v_exp_f32 v66, v66
    v_exp_f32 v67, v67
    v_exp_f32 v68, v68
    v_exp_f32 v69, v69
    v_exp_f32 v70, v70
    v_exp_f32 v71, v71
    s_nop 0
    v_cvt_pk_bf16_f32 v72, v64, v65
    v_cvt_pk_bf16_f32 v73, v66, v67
    v_cvt_pk_bf16_f32 v74, v68, v69
    v_cvt_pk_bf16_f32 v75, v70, v71
    v_add_f32 v10, v10, v64
    v_add_f32 v10, v10, v65
    v_add_f32 v10, v10, v66
    v_add_f32 v10, v10, v67
    v_add_f32 v10, v10, v68
    v_add_f32 v10, v10, v69
    v_add_f32 v10, v10, v70
    v_add_f32 v10, v10, v71
    s_waitcnt vmcnt(32)
    v_perm_b32 v76, v196, v192, s44
    v_perm_b32 v77, v204, v200, s44
    v_perm_b32 v78, v212, v208, s44
    v_perm_b32 v79, v220, v216, s44
    v_perm_b32 v80, v196, v192, s45
    v_perm_b32 v81, v204, v200, s45
    v_perm_b32 v82, v212, v208, s45
    v_perm_b32 v83, v220, v216, s45
    v_perm_b32 v84, v197, v193, s44
    v_perm_b32 v85, v205, v201, s44
    v_perm_b32 v86, v213, v209, s44
    v_perm_b32 v87, v221, v217, s44
    v_perm_b32 v88, v197, v193, s45
    v_perm_b32 v89, v205, v201, s45
    v_perm_b32 v90, v213, v209, s45
    v_perm_b32 v91, v221, v217, s45
    v_mfma_f32_16x16x32_bf16 v[32:35], v[76:79], v[72:75], v[32:35]
    v_mfma_f32_16x16x32_bf16 v[36:39], v[80:83], v[72:75], v[36:39]
    v_perm_b32 v76, v198, v194, s44
    v_perm_b32 v77, v206, v202, s44
    v_perm_b32 v78, v214, v210, s44
    v_perm_b32 v79, v222, v218, s44
    v_perm_b32 v80, v198, v194, s45
    v_perm_b32 v81, v206, v202, s45
    v_perm_b32 v82, v214, v210, s45
    v_perm_b32 v83, v222, v218, s45
    v_mfma_f32_16x16x32_bf16 v[40:43], v[84:87], v[72:75], v[40:43]
    v_mfma_f32_16x16x32_bf16 v[44:47], v[88:91], v[72:75], v[44:47]
    v_perm_b32 v84, v199, v195, s44
    v_perm_b32 v85, v207, v203, s44
    v_perm_b32 v86, v215, v211, s44
    v_perm_b32 v87, v223, v219, s44
    v_perm_b32 v88, v199, v195, s45
    v_perm_b32 v89, v207, v203, s45
    v_perm_b32 v90, v215, v211, s45
    v_perm_b32 v91, v223, v219, s45
    s_add_u32 s48, s40, 0x18000
    s_add_u32 s49, s40, 0x19000
    buffer_load_dwordx4 v[192:195], v5, s[20:23], s48 offen offset:0 nt
    buffer_load_dwordx4 v[196:199], v5, s[20:23], s48 offen offset:64 nt
    buffer_load_dwordx4 v[200:203], v5, s[20:23], s48 offen offset:128 nt
    buffer_load_dwordx4 v[204:207], v5, s[20:23], s48 offen offset:192 nt
    buffer_load_dwordx4 v[208:211], v5, s[20:23], s49 offen offset:0 nt
    buffer_load_dwordx4 v[212:215], v5, s[20:23], s49 offen offset:64 nt
    buffer_load_dwordx4 v[216:219], v5, s[20:23], s49 offen offset:128 nt
    buffer_load_dwordx4 v[220:223], v5, s[20:23], s49 offen offset:192 nt
    v_mfma_f32_16x16x32_bf16 v[48:51], v[76:79], v[72:75], v[48:51]
    v_mfma_f32_16x16x32_bf16 v[52:55], v[80:83], v[72:75], v[52:55]
    s_nop 1
    v_mfma_f32_16x16x32_bf16 v[56:59], v[84:87], v[72:75], v[56:59]
    v_mfma_f32_16x16x32_bf16 v[60:63], v[88:91], v[72:75], v[60:63]
    s_waitcnt vmcnt(32)
    v_mfma_f32_16x16x32_bf16 v[64:67], v[224:227], v[16:19], 0
    v_mfma_f32_16x16x32_bf16 v[68:71], v[240:243], v[16:19], 0
    v_mfma_f32_16x16x32_bf16 v[64:67], v[228:231], v[20:23], v[64:67]
    v_mfma_f32_16x16x32_bf16 v[68:71], v[244:247], v[20:23], v[68:71]
    v_mfma_f32_16x16x32_bf16 v[64:67], v[232:235], v[24:27], v[64:67]
    v_mfma_f32_16x16x32_bf16 v[68:71], v[248:251], v[24:27], v[68:71]
    v_mfma_f32_16x16x32_bf16 v[64:67], v[236:239], v[28:31], v[64:67]
    v_mfma_f32_16x16x32_bf16 v[68:71], v[252:255], v[28:31], v[68:71]
    s_add_u32 s48, s40, 0x18000
    s_add_u32 s49, s40, 0x19000
    buffer_load_dwordx4 v[224:227], v6, s[24:27], s48 offen offset:0 nt
    buffer_load_dwordx4 v[228:231], v6, s[24:27], s48 offen offset:256 nt
    buffer_load_dwordx4 v[232:235], v6, s[24:27], s48 offen offset:512 nt
    buffer_load_dwordx4 v[236:239], v6, s[24:27], s48 offen offset:768 nt
    buffer_load_dwordx4 v[240:243], v6, s[24:27], s49 offen offset:0 nt
    buffer_load_dwordx4 v[244:247], v6, s[24:27], s49 offen offset:256 nt
    buffer_load_dwordx4 v[248:251], v6, s[24:27], s49 offen offset:512 nt
    buffer_load_dwordx4 v[252:255], v6, s[24:27], s49 offen offset:768 nt
    v_max3_f32 v12, v64, v65, v66
    v_max3_f32 v14, v67, v68, v69
    v_max3_f32 v12, v12, v70, v71
    v_max_f32 v12, v12, v14
    v_mov_b32 v13, v12
    s_nop 1
    v_permlane32_swap_b32 v12, v13
    v_max_f32 v12, v12, v13
    v_mov_b32 v13, v12
    s_nop 1
    v_permlane16_swap_b32 v12, v13
    v_max3_f32 v12, v12, v13, v9
    v_cmp_gt_f32 vcc, v12, v9
    s_cbranch_vccz L_nors_a_2
    v_sub_f32 v15, v9, v12
    v_mul_f32 v15, s46, v15
    v_exp_f32 v15, v15
    s_nop 0
    v_mul_f32 v10, v10, v15
    v_mul_f32 v32, v32, v15
    v_mul_f32 v33, v33, v15
    v_mul_f32 v34, v34, v15
    v_mul_f32 v35, v35, v15
    v_mul_f32 v36, v36, v15
    v_mul_f32 v37, v37, v15
    v_mul_f32 v38, v38, v15
    v_mul_f32 v39, v39, v15
    v_mul_f32 v40, v40, v15
    v_mul_f32 v41, v41, v15
    v_mul_f32 v42, v42, v15
    v_mul_f32 v43, v43, v15
    v_mul_f32 v44, v44, v15
    v_mul_f32 v45, v45, v15
    v_mul_f32 v46, v46, v15
    v_mul_f32 v47, v47, v15
    v_mul_f32 v48, v48, v15
    v_mul_f32 v49, v49, v15
    v_mul_f32 v50, v50, v15
    v_mul_f32 v51, v51, v15
    v_mul_f32 v52, v52, v15
    v_mul_f32 v53, v53, v15
    v_mul_f32 v54, v54, v15
    v_mul_f32 v55, v55, v15
    v_mul_f32 v56, v56, v15
    v_mul_f32 v57, v57, v15
    v_mul_f32 v58, v58, v15
    v_mul_f32 v59, v59, v15
    v_mul_f32 v60, v60, v15
    v_mul_f32 v61, v61, v15
    v_mul_f32 v62, v62, v15
    v_mul_f32 v63, v63, v15
L_nors_a_2:
    v_mov_b32 v9, v12
    v_mul_f32 v11, s46, v12
    v_fma_f32 v64, v64, s46, -v11
    v_fma_f32 v65, v65, s46, -v11
    v_fma_f32 v66, v66, s46, -v11
    v_fma_f32 v67, v67, s46, -v11
    v_fma_f32 v68, v68, s46, -v11
    v_fma_f32 v69, v69, s46, -v11
    v_fma_f32 v70, v70, s46, -v11
    v_fma_f32 v71, v71, s46, -v11
    v_exp_f32 v64, v64
    v_exp_f32 v65, v65
    v_exp_f32 v66, v66
    v_exp_f32 v67, v67
    v_exp_f32 v68, v68
    v_exp_f32 v69, v69
    v_exp_f32 v70, v70
    v_exp_f32 v71, v71
    s_nop 0
    v_cvt_pk_bf16_f32 v72, v64, v65
    v_cvt_pk_bf16_f32 v73, v66, v67
    v_cvt_pk_bf16_f32 v74, v68, v69
    v_cvt_pk_bf16_f32 v75, v70, v71
    v_add_f32 v10, v10, v64
    v_add_f32 v10, v10, v65
    v_add_f32 v10, v10, v66
    v_add_f32 v10, v10, v67
    v_add_f32 v10, v10, v68
    v_add_f32 v10, v10, v69
    v_add_f32 v10, v10, v70
    v_add_f32 v10, v10, v71
    s_waitcnt vmcnt(32)
    v_perm_b32 v76, v100, v96, s44
    v_perm_b32 v77, v108, v104, s44
    v_perm_b32 v78, v116, v112, s44
    v_perm_b32 v79, v124, v120, s44
    v_perm_b32 v80, v100, v96, s45
    v_perm_b32 v81, v108, v104, s45
    v_perm_b32 v82, v116, v112, s45
    v_perm_b32 v83, v124, v120, s45
    v_perm_b32 v84, v101, v97, s44
    v_perm_b32 v85, v109, v105, s44
    v_perm_b32 v86, v117, v113, s44
    v_perm_b32 v87, v125, v121, s44
    v_perm_b32 v88, v101, v97, s45
    v_perm_b32 v89, v109, v105, s45
    v_perm_b32 v90, v117, v113, s45
    v_perm_b32 v91, v125, v121, s45
    v_mfma_f32_16x16x32_bf16 v[32:35], v[76:79], v[72:75], v[32:35]
    v_mfma_f32_16x16x32_bf16 v[36:39], v[80:83], v[72:75], v[36:39]
    v_perm_b32 v76, v102, v98, s44
    v_perm_b32 v77, v110, v106, s44
    v_perm_b32 v78, v118, v114, s44
    v_perm_b32 v79, v126, v122, s44
    v_perm_b32 v80, v102, v98, s45
    v_perm_b32 v81, v110, v106, s45
    v_perm_b32 v82, v118, v114, s45
    v_perm_b32 v83, v126, v122, s45
    v_mfma_f32_16x16x32_bf16 v[40:43], v[84:87], v[72:75], v[40:43]
    v_mfma_f32_16x16x32_bf16 v[44:47], v[88:91], v[72:75], v[44:47]
    v_perm_b32 v84, v103, v99, s44
    v_perm_b32 v85, v111, v107, s44
    v_perm_b32 v86, v119, v115, s44
    v_perm_b32 v87, v127, v123, s44
    v_perm_b32 v88, v103, v99, s45
    v_perm_b32 v89, v111, v107, s45
    v_perm_b32 v90, v119, v115, s45
    v_perm_b32 v91, v127, v123, s45
    s_add_u32 s48, s40, 0x20000
    s_add_u32 s49, s40, 0x21000
    buffer_load_dwordx4 v[96:99], v5, s[20:23], s48 offen offset:0 nt
    buffer_load_dwordx4 v[100:103], v5, s[20:23], s48 offen offset:64 nt
    buffer_load_dwordx4 v[104:107], v5, s[20:23], s48 offen offset:128 nt
    buffer_load_dwordx4 v[108:111], v5, s[20:23], s48 offen offset:192 nt
    buffer_load_dwordx4 v[112:115], v5, s[20:23], s49 offen offset:0 nt
    buffer_load_dwordx4 v[116:119], v5, s[20:23], s49 offen offset:64 nt
    buffer_load_dwordx4 v[120:123], v5, s[20:23], s49 offen offset:128 nt
    buffer_load_dwordx4 v[124:127], v5, s[20:23], s49 offen offset:192 nt
    v_mfma_f32_16x16x32_bf16 v[48:51], v[76:79], v[72:75], v[48:51]
    v_mfma_f32_16x16x32_bf16 v[52:55], v[80:83], v[72:75], v[52:55]
    s_nop 1
    v_mfma_f32_16x16x32_bf16 v[56:59], v[84:87], v[72:75], v[56:59]
    v_mfma_f32_16x16x32_bf16 v[60:63], v[88:91], v[72:75], v[60:63]
    s_waitcnt vmcnt(32)
    v_mfma_f32_16x16x32_bf16 v[64:67], v[128:131], v[16:19], 0
    v_mfma_f32_16x16x32_bf16 v[68:71], v[144:147], v[16:19], 0
    v_mfma_f32_16x16x32_bf16 v[64:67], v[132:135], v[20:23], v[64:67]
    v_mfma_f32_16x16x32_bf16 v[68:71], v[148:151], v[20:23], v[68:71]
    v_mfma_f32_16x16x32_bf16 v[64:67], v[136:139], v[24:27], v[64:67]
    v_mfma_f32_16x16x32_bf16 v[68:71], v[152:155], v[24:27], v[68:71]
    v_mfma_f32_16x16x32_bf16 v[64:67], v[140:143], v[28:31], v[64:67]
    v_mfma_f32_16x16x32_bf16 v[68:71], v[156:159], v[28:31], v[68:71]
    s_add_u32 s48, s40, 0x20000
    s_add_u32 s49, s40, 0x21000
    buffer_load_dwordx4 v[128:131], v6, s[24:27], s48 offen offset:0 nt
    buffer_load_dwordx4 v[132:135], v6, s[24:27], s48 offen offset:256 nt
    buffer_load_dwordx4 v[136:139], v6, s[24:27], s48 offen offset:512 nt
    buffer_load_dwordx4 v[140:143], v6, s[24:27], s48 offen offset:768 nt
    buffer_load_dwordx4 v[144:147], v6, s[24:27], s49 offen offset:0 nt
    buffer_load_dwordx4 v[148:151], v6, s[24:27], s49 offen offset:256 nt
    buffer_load_dwordx4 v[152:155], v6, s[24:27], s49 offen offset:512 nt
    buffer_load_dwordx4 v[156:159], v6, s[24:27], s49 offen offset:768 nt
    v_max3_f32 v12, v64, v65, v66
    v_max3_f32 v14, v67, v68, v69
    v_max3_f32 v12, v12, v70, v71
    v_max_f32 v12, v12, v14
    v_mov_b32 v13, v12
    s_nop 1
    v_permlane32_swap_b32 v12, v13
    v_max_f32 v12, v12, v13
    v_mov_b32 v13, v12
    s_nop 1
    v_permlane16_swap_b32 v12, v13
    v_max3_f32 v12, v12, v13, v9
    v_cmp_gt_f32 vcc, v12, v9
    s_cbranch_vccz L_nors_a_3
    v_sub_f32 v15, v9, v12
    v_mul_f32 v15, s46, v15
    v_exp_f32 v15, v15
    s_nop 0
    v_mul_f32 v10, v10, v15
    v_mul_f32 v32, v32, v15
    v_mul_f32 v33, v33, v15
    v_mul_f32 v34, v34, v15
    v_mul_f32 v35, v35, v15
    v_mul_f32 v36, v36, v15
    v_mul_f32 v37, v37, v15
    v_mul_f32 v38, v38, v15
    v_mul_f32 v39, v39, v15
    v_mul_f32 v40, v40, v15
    v_mul_f32 v41, v41, v15
    v_mul_f32 v42, v42, v15
    v_mul_f32 v43, v43, v15
    v_mul_f32 v44, v44, v15
    v_mul_f32 v45, v45, v15
    v_mul_f32 v46, v46, v15
    v_mul_f32 v47, v47, v15
    v_mul_f32 v48, v48, v15
    v_mul_f32 v49, v49, v15
    v_mul_f32 v50, v50, v15
    v_mul_f32 v51, v51, v15
    v_mul_f32 v52, v52, v15
    v_mul_f32 v53, v53, v15
    v_mul_f32 v54, v54, v15
    v_mul_f32 v55, v55, v15
    v_mul_f32 v56, v56, v15
    v_mul_f32 v57, v57, v15
    v_mul_f32 v58, v58, v15
    v_mul_f32 v59, v59, v15
    v_mul_f32 v60, v60, v15
    v_mul_f32 v61, v61, v15
    v_mul_f32 v62, v62, v15
    v_mul_f32 v63, v63, v15
L_nors_a_3:
    v_mov_b32 v9, v12
    v_mul_f32 v11, s46, v12
    v_fma_f32 v64, v64, s46, -v11
    v_fma_f32 v65, v65, s46, -v11
    v_fma_f32 v66, v66, s46, -v11
    v_fma_f32 v67, v67, s46, -v11
    v_fma_f32 v68, v68, s46, -v11
    v_fma_f32 v69, v69, s46, -v11
    v_fma_f32 v70, v70, s46, -v11
    v_fma_f32 v71, v71, s46, -v11
    v_exp_f32 v64, v64
    v_exp_f32 v65, v65
    v_exp_f32 v66, v66
    v_exp_f32 v67, v67
    v_exp_f32 v68, v68
    v_exp_f32 v69, v69
    v_exp_f32 v70, v70
    v_exp_f32 v71, v71
    s_nop 0
    v_cvt_pk_bf16_f32 v72, v64, v65
    v_cvt_pk_bf16_f32 v73, v66, v67
    v_cvt_pk_bf16_f32 v74, v68, v69
    v_cvt_pk_bf16_f32 v75, v70, v71
    v_add_f32 v10, v10, v64
    v_add_f32 v10, v10, v65
    v_add_f32 v10, v10, v66
    v_add_f32 v10, v10, v67
    v_add_f32 v10, v10, v68
    v_add_f32 v10, v10, v69
    v_add_f32 v10, v10, v70
    v_add_f32 v10, v10, v71
    s_waitcnt vmcnt(32)
    v_perm_b32 v76, v164, v160, s44
    v_perm_b32 v77, v172, v168, s44
    v_perm_b32 v78, v180, v176, s44
    v_perm_b32 v79, v188, v184, s44
    v_perm_b32 v80, v164, v160, s45
    v_perm_b32 v81, v172, v168, s45
    v_perm_b32 v82, v180, v176, s45
    v_perm_b32 v83, v188, v184, s45
    v_perm_b32 v84, v165, v161, s44
    v_perm_b32 v85, v173, v169, s44
    v_perm_b32 v86, v181, v177, s44
    v_perm_b32 v87, v189, v185, s44
    v_perm_b32 v88, v165, v161, s45
    v_perm_b32 v89, v173, v169, s45
    v_perm_b32 v90, v181, v177, s45
    v_perm_b32 v91, v189, v185, s45
    v_mfma_f32_16x16x32_bf16 v[32:35], v[76:79], v[72:75], v[32:35]
    v_mfma_f32_16x16x32_bf16 v[36:39], v[80:83], v[72:75], v[36:39]
    v_perm_b32 v76, v166, v162, s44
    v_perm_b32 v77, v174, v170, s44
    v_perm_b32 v78, v182, v178, s44
    v_perm_b32 v79, v190, v186, s44
    v_perm_b32 v80, v166, v162, s45
    v_perm_b32 v81, v174, v170, s45
    v_perm_b32 v82, v182, v178, s45
    v_perm_b32 v83, v190, v186, s45
    v_mfma_f32_16x16x32_bf16 v[40:43], v[84:87], v[72:75], v[40:43]
    v_mfma_f32_16x16x32_bf16 v[44:47], v[88:91], v[72:75], v[44:47]
    v_perm_b32 v84, v167, v163, s44
    v_perm_b32 v85, v175, v171, s44
    v_perm_b32 v86, v183, v179, s44
    v_perm_b32 v87, v191, v187, s44
    v_perm_b32 v88, v167, v163, s45
    v_perm_b32 v89, v175, v171, s45
    v_perm_b32 v90, v183, v179, s45
    v_perm_b32 v91, v191, v187, s45
    s_add_u32 s48, s40, 0x28000
    s_add_u32 s49, s40, 0x29000
    buffer_load_dwordx4 v[160:163], v5, s[20:23], s48 offen offset:0 nt
    buffer_load_dwordx4 v[164:167], v5, s[20:23], s48 offen offset:64 nt
    buffer_load_dwordx4 v[168:171], v5, s[20:23], s48 offen offset:128 nt
    buffer_load_dwordx4 v[172:175], v5, s[20:23], s48 offen offset:192 nt
    buffer_load_dwordx4 v[176:179], v5, s[20:23], s49 offen offset:0 nt
    buffer_load_dwordx4 v[180:183], v5, s[20:23], s49 offen offset:64 nt
    buffer_load_dwordx4 v[184:187], v5, s[20:23], s49 offen offset:128 nt
    buffer_load_dwordx4 v[188:191], v5, s[20:23], s49 offen offset:192 nt
    v_mfma_f32_16x16x32_bf16 v[48:51], v[76:79], v[72:75], v[48:51]
    v_mfma_f32_16x16x32_bf16 v[52:55], v[80:83], v[72:75], v[52:55]
    s_nop 1
    v_mfma_f32_16x16x32_bf16 v[56:59], v[84:87], v[72:75], v[56:59]
    v_mfma_f32_16x16x32_bf16 v[60:63], v[88:91], v[72:75], v[60:63]
    s_waitcnt vmcnt(32)
    v_mfma_f32_16x16x32_bf16 v[64:67], v[192:195], v[16:19], 0
    v_mfma_f32_16x16x32_bf16 v[68:71], v[208:211], v[16:19], 0
    v_mfma_f32_16x16x32_bf16 v[64:67], v[196:199], v[20:23], v[64:67]
    v_mfma_f32_16x16x32_bf16 v[68:71], v[212:215], v[20:23], v[68:71]
    v_mfma_f32_16x16x32_bf16 v[64:67], v[200:203], v[24:27], v[64:67]
    v_mfma_f32_16x16x32_bf16 v[68:71], v[216:219], v[24:27], v[68:71]
    v_mfma_f32_16x16x32_bf16 v[64:67], v[204:207], v[28:31], v[64:67]
    v_mfma_f32_16x16x32_bf16 v[68:71], v[220:223], v[28:31], v[68:71]
    s_add_u32 s48, s40, 0x28000
    s_add_u32 s49, s40, 0x29000
    buffer_load_dwordx4 v[192:195], v6, s[24:27], s48 offen offset:0 nt
    buffer_load_dwordx4 v[196:199], v6, s[24:27], s48 offen offset:256 nt
    buffer_load_dwordx4 v[200:203], v6, s[24:27], s48 offen offset:512 nt
    buffer_load_dwordx4 v[204:207], v6, s[24:27], s48 offen offset:768 nt
    buffer_load_dwordx4 v[208:211], v6, s[24:27], s49 offen offset:0 nt
    buffer_load_dwordx4 v[212:215], v6, s[24:27], s49 offen offset:256 nt
    buffer_load_dwordx4 v[216:219], v6, s[24:27], s49 offen offset:512 nt
    buffer_load_dwordx4 v[220:223], v6, s[24:27], s49 offen offset:768 nt
    v_max3_f32 v12, v64, v65, v66
    v_max3_f32 v14, v67, v68, v69
    v_max3_f32 v12, v12, v70, v71
    v_max_f32 v12, v12, v14
    v_mov_b32 v13, v12
    s_nop 1
    v_permlane32_swap_b32 v12, v13
    v_max_f32 v12, v12, v13
    v_mov_b32 v13, v12
    s_nop 1
    v_permlane16_swap_b32 v12, v13
    v_max3_f32 v12, v12, v13, v9
    v_cmp_gt_f32 vcc, v12, v9
    s_cbranch_vccz L_nors_a_4
    v_sub_f32 v15, v9, v12
    v_mul_f32 v15, s46, v15
    v_exp_f32 v15, v15
    s_nop 0
    v_mul_f32 v10, v10, v15
    v_mul_f32 v32, v32, v15
    v_mul_f32 v33, v33, v15
    v_mul_f32 v34, v34, v15
    v_mul_f32 v35, v35, v15
    v_mul_f32 v36, v36, v15
    v_mul_f32 v37, v37, v15
    v_mul_f32 v38, v38, v15
    v_mul_f32 v39, v39, v15
    v_mul_f32 v40, v40, v15
    v_mul_f32 v41, v41, v15
    v_mul_f32 v42, v42, v15
    v_mul_f32 v43, v43, v15
    v_mul_f32 v44, v44, v15
    v_mul_f32 v45, v45, v15
    v_mul_f32 v46, v46, v15
    v_mul_f32 v47, v47, v15
    v_mul_f32 v48, v48, v15
    v_mul_f32 v49, v49, v15
    v_mul_f32 v50, v50, v15
    v_mul_f32 v51, v51, v15
    v_mul_f32 v52, v52, v15
    v_mul_f32 v53, v53, v15
    v_mul_f32 v54, v54, v15
    v_mul_f32 v55, v55, v15
    v_mul_f32 v56, v56, v15
    v_mul_f32 v57, v57, v15
    v_mul_f32 v58, v58, v15
    v_mul_f32 v59, v59, v15
    v_mul_f32 v60, v60, v15
    v_mul_f32 v61, v61, v15
    v_mul_f32 v62, v62, v15
    v_mul_f32 v63, v63, v15
L_nors_a_4:
    v_mov_b32 v9, v12
    v_mul_f32 v11, s46, v12
    v_fma_f32 v64, v64, s46, -v11
    v_fma_f32 v65, v65, s46, -v11
    v_fma_f32 v66, v66, s46, -v11
    v_fma_f32 v67, v67, s46, -v11
    v_fma_f32 v68, v68, s46, -v11
    v_fma_f32 v69, v69, s46, -v11
    v_fma_f32 v70, v70, s46, -v11
    v_fma_f32 v71, v71, s46, -v11
    v_exp_f32 v64, v64
    v_exp_f32 v65, v65
    v_exp_f32 v66, v66
    v_exp_f32 v67, v67
    v_exp_f32 v68, v68
    v_exp_f32 v69, v69
    v_exp_f32 v70, v70
    v_exp_f32 v71, v71
    s_nop 0
    v_cvt_pk_bf16_f32 v72, v64, v65
    v_cvt_pk_bf16_f32 v73, v66, v67
    v_cvt_pk_bf16_f32 v74, v68, v69
    v_cvt_pk_bf16_f32 v75, v70, v71
    v_add_f32 v10, v10, v64
    v_add_f32 v10, v10, v65
    v_add_f32 v10, v10, v66
    v_add_f32 v10, v10, v67
    v_add_f32 v10, v10, v68
    v_add_f32 v10, v10, v69
    v_add_f32 v10, v10, v70
    v_add_f32 v10, v10, v71
    s_waitcnt vmcnt(32)
    v_perm_b32 v76, v228, v224, s44
    v_perm_b32 v77, v236, v232, s44
    v_perm_b32 v78, v244, v240, s44
    v_perm_b32 v79, v252, v248, s44
    v_perm_b32 v80, v228, v224, s45
    v_perm_b32 v81, v236, v232, s45
    v_perm_b32 v82, v244, v240, s45
    v_perm_b32 v83, v252, v248, s45
    v_perm_b32 v84, v229, v225, s44
    v_perm_b32 v85, v237, v233, s44
    v_perm_b32 v86, v245, v241, s44
    v_perm_b32 v87, v253, v249, s44
    v_perm_b32 v88, v229, v225, s45
    v_perm_b32 v89, v237, v233, s45
    v_perm_b32 v90, v245, v241, s45
    v_perm_b32 v91, v253, v249, s45
    v_mfma_f32_16x16x32_bf16 v[32:35], v[76:79], v[72:75], v[32:35]
    v_mfma_f32_16x16x32_bf16 v[36:39], v[80:83], v[72:75], v[36:39]
    v_perm_b32 v76, v230, v226, s44
    v_perm_b32 v77, v238, v234, s44
    v_perm_b32 v78, v246, v242, s44
    v_perm_b32 v79, v254, v250, s44
    v_perm_b32 v80, v230, v226, s45
    v_perm_b32 v81, v238, v234, s45
    v_perm_b32 v82, v246, v242, s45
    v_perm_b32 v83, v254, v250, s45
    v_mfma_f32_16x16x32_bf16 v[40:43], v[84:87], v[72:75], v[40:43]
    v_mfma_f32_16x16x32_bf16 v[44:47], v[88:91], v[72:75], v[44:47]
    v_perm_b32 v84, v231, v227, s44
    v_perm_b32 v85, v239, v235, s44
    v_perm_b32 v86, v247, v243, s44
    v_perm_b32 v87, v255, v251, s44
    v_perm_b32 v88, v231, v227, s45
    v_perm_b32 v89, v239, v235, s45
    v_perm_b32 v90, v247, v243, s45
    v_perm_b32 v91, v255, v251, s45
    s_add_u32 s48, s40, 0x30000
    s_add_u32 s49, s40, 0x31000
    buffer_load_dwordx4 v[224:227], v5, s[20:23], s48 offen offset:0 nt
    buffer_load_dwordx4 v[228:231], v5, s[20:23], s48 offen offset:64 nt
    buffer_load_dwordx4 v[232:235], v5, s[20:23], s48 offen offset:128 nt
    buffer_load_dwordx4 v[236:239], v5, s[20:23], s48 offen offset:192 nt
    buffer_load_dwordx4 v[240:243], v5, s[20:23], s49 offen offset:0 nt
    buffer_load_dwordx4 v[244:247], v5, s[20:23], s49 offen offset:64 nt
    buffer_load_dwordx4 v[248:251], v5, s[20:23], s49 offen offset:128 nt
    buffer_load_dwordx4 v[252:255], v5, s[20:23], s49 offen offset:192 nt
    v_mfma_f32_16x16x32_bf16 v[48:51], v[76:79], v[72:75], v[48:51]
    v_mfma_f32_16x16x32_bf16 v[52:55], v[80:83], v[72:75], v[52:55]
    s_nop 1
    v_mfma_f32_16x16x32_bf16 v[56:59], v[84:87], v[72:75], v[56:59]
    v_mfma_f32_16x16x32_bf16 v[60:63], v[88:91], v[72:75], v[60:63]
    s_waitcnt vmcnt(32)
    v_mfma_f32_16x16x32_bf16 v[64:67], v[96:99], v[16:19], 0
    v_mfma_f32_16x16x32_bf16 v[68:71], v[112:115], v[16:19], 0
    v_mfma_f32_16x16x32_bf16 v[64:67], v[100:103], v[20:23], v[64:67]
    v_mfma_f32_16x16x32_bf16 v[68:71], v[116:119], v[20:23], v[68:71]
    v_mfma_f32_16x16x32_bf16 v[64:67], v[104:107], v[24:27], v[64:67]
    v_mfma_f32_16x16x32_bf16 v[68:71], v[120:123], v[24:27], v[68:71]
    v_mfma_f32_16x16x32_bf16 v[64:67], v[108:111], v[28:31], v[64:67]
    v_mfma_f32_16x16x32_bf16 v[68:71], v[124:127], v[28:31], v[68:71]
    s_add_u32 s48, s40, 0x30000
    s_add_u32 s49, s40, 0x31000
    buffer_load_dwordx4 v[96:99], v6, s[24:27], s48 offen offset:0 nt
    buffer_load_dwordx4 v[100:103], v6, s[24:27], s48 offen offset:256 nt
    buffer_load_dwordx4 v[104:107], v6, s[24:27], s48 offen offset:512 nt
    buffer_load_dwordx4 v[108:111], v6, s[24:27], s48 offen offset:768 nt
    buffer_load_dwordx4 v[112:115], v6, s[24:27], s49 offen offset:0 nt
    buffer_load_dwordx4 v[116:119], v6, s[24:27], s49 offen offset:256 nt
    buffer_load_dwordx4 v[120:123], v6, s[24:27], s49 offen offset:512 nt
    buffer_load_dwordx4 v[124:127], v6, s[24:27], s49 offen offset:768 nt
    v_max3_f32 v12, v64, v65, v66
    v_max3_f32 v14, v67, v68, v69
    v_max3_f32 v12, v12, v70, v71
    v_max_f32 v12, v12, v14
    v_mov_b32 v13, v12
    s_nop 1
    v_permlane32_swap_b32 v12, v13
    v_max_f32 v12, v12, v13
    v_mov_b32 v13, v12
    s_nop 1
    v_permlane16_swap_b32 v12, v13
    v_max3_f32 v12, v12, v13, v9
    v_cmp_gt_f32 vcc, v12, v9
    s_cbranch_vccz L_nors_a_5
    v_sub_f32 v15, v9, v12
    v_mul_f32 v15, s46, v15
    v_exp_f32 v15, v15
    s_nop 0
    v_mul_f32 v10, v10, v15
    v_mul_f32 v32, v32, v15
    v_mul_f32 v33, v33, v15
    v_mul_f32 v34, v34, v15
    v_mul_f32 v35, v35, v15
    v_mul_f32 v36, v36, v15
    v_mul_f32 v37, v37, v15
    v_mul_f32 v38, v38, v15
    v_mul_f32 v39, v39, v15
    v_mul_f32 v40, v40, v15
    v_mul_f32 v41, v41, v15
    v_mul_f32 v42, v42, v15
    v_mul_f32 v43, v43, v15
    v_mul_f32 v44, v44, v15
    v_mul_f32 v45, v45, v15
    v_mul_f32 v46, v46, v15
    v_mul_f32 v47, v47, v15
    v_mul_f32 v48, v48, v15
    v_mul_f32 v49, v49, v15
    v_mul_f32 v50, v50, v15
    v_mul_f32 v51, v51, v15
    v_mul_f32 v52, v52, v15
    v_mul_f32 v53, v53, v15
    v_mul_f32 v54, v54, v15
    v_mul_f32 v55, v55, v15
    v_mul_f32 v56, v56, v15
    v_mul_f32 v57, v57, v15
    v_mul_f32 v58, v58, v15
    v_mul_f32 v59, v59, v15
    v_mul_f32 v60, v60, v15
    v_mul_f32 v61, v61, v15
    v_mul_f32 v62, v62, v15
    v_mul_f32 v63, v63, v15
L_nors_a_5:
    v_mov_b32 v9, v12
    v_mul_f32 v11, s46, v12
    v_fma_f32 v64, v64, s46, -v11
    v_fma_f32 v65, v65, s46, -v11
    v_fma_f32 v66, v66, s46, -v11
    v_fma_f32 v67, v67, s46, -v11
    v_fma_f32 v68, v68, s46, -v11
    v_fma_f32 v69, v69, s46, -v11
    v_fma_f32 v70, v70, s46, -v11
    v_fma_f32 v71, v71, s46, -v11
    v_exp_f32 v64, v64
    v_exp_f32 v65, v65
    v_exp_f32 v66, v66
    v_exp_f32 v67, v67
    v_exp_f32 v68, v68
    v_exp_f32 v69, v69
    v_exp_f32 v70, v70
    v_exp_f32 v71, v71
    s_nop 0
    v_cvt_pk_bf16_f32 v72, v64, v65
    v_cvt_pk_bf16_f32 v73, v66, v67
    v_cvt_pk_bf16_f32 v74, v68, v69
    v_cvt_pk_bf16_f32 v75, v70, v71
    v_add_f32 v10, v10, v64
    v_add_f32 v10, v10, v65
    v_add_f32 v10, v10, v66
    v_add_f32 v10, v10, v67
    v_add_f32 v10, v10, v68
    v_add_f32 v10, v10, v69
    v_add_f32 v10, v10, v70
    v_add_f32 v10, v10, v71
    s_waitcnt vmcnt(32)
    v_perm_b32 v76, v132, v128, s44
    v_perm_b32 v77, v140, v136, s44
    v_perm_b32 v78, v148, v144, s44
    v_perm_b32 v79, v156, v152, s44
    v_perm_b32 v80, v132, v128, s45
    v_perm_b32 v81, v140, v136, s45
    v_perm_b32 v82, v148, v144, s45
    v_perm_b32 v83, v156, v152, s45
    v_perm_b32 v84, v133, v129, s44
    v_perm_b32 v85, v141, v137, s44
    v_perm_b32 v86, v149, v145, s44
    v_perm_b32 v87, v157, v153, s44
    v_perm_b32 v88, v133, v129, s45
    v_perm_b32 v89, v141, v137, s45
    v_perm_b32 v90, v149, v145, s45
    v_perm_b32 v91, v157, v153, s45
    v_mfma_f32_16x16x32_bf16 v[32:35], v[76:79], v[72:75], v[32:35]
    v_mfma_f32_16x16x32_bf16 v[36:39], v[80:83], v[72:75], v[36:39]
    v_perm_b32 v76, v134, v130, s44
    v_perm_b32 v77, v142, v138, s44
    v_perm_b32 v78, v150, v146, s44
    v_perm_b32 v79, v158, v154, s44
    v_perm_b32 v80, v134, v130, s45
    v_perm_b32 v81, v142, v138, s45
    v_perm_b32 v82, v150, v146, s45
    v_perm_b32 v83, v158, v154, s45
    v_mfma_f32_16x16x32_bf16 v[40:43], v[84:87], v[72:75], v[40:43]
    v_mfma_f32_16x16x32_bf16 v[44:47], v[88:91], v[72:75], v[44:47]
    v_perm_b32 v84, v135, v131, s44
    v_perm_b32 v85, v143, v139, s44
    v_perm_b32 v86, v151, v147, s44
    v_perm_b32 v87, v159, v155, s44
    v_perm_b32 v88, v135, v131, s45
    v_perm_b32 v89, v143, v139, s45
    v_perm_b32 v90, v151, v147, s45
    v_perm_b32 v91, v159, v155, s45
    s_add_u32 s48, s40, 0x38000
    s_add_u32 s49, s40, 0x39000
    buffer_load_dwordx4 v[128:131], v5, s[20:23], s48 offen offset:0 nt
    buffer_load_dwordx4 v[132:135], v5, s[20:23], s48 offen offset:64 nt
    buffer_load_dwordx4 v[136:139], v5, s[20:23], s48 offen offset:128 nt
    buffer_load_dwordx4 v[140:143], v5, s[20:23], s48 offen offset:192 nt
    buffer_load_dwordx4 v[144:147], v5, s[20:23], s49 offen offset:0 nt
    buffer_load_dwordx4 v[148:151], v5, s[20:23], s49 offen offset:64 nt
    buffer_load_dwordx4 v[152:155], v5, s[20:23], s49 offen offset:128 nt
    buffer_load_dwordx4 v[156:159], v5, s[20:23], s49 offen offset:192 nt
    v_mfma_f32_16x16x32_bf16 v[48:51], v[76:79], v[72:75], v[48:51]
    v_mfma_f32_16x16x32_bf16 v[52:55], v[80:83], v[72:75], v[52:55]
    s_nop 1
    v_mfma_f32_16x16x32_bf16 v[56:59], v[84:87], v[72:75], v[56:59]
    v_mfma_f32_16x16x32_bf16 v[60:63], v[88:91], v[72:75], v[60:63]
    s_waitcnt vmcnt(32)
    v_mfma_f32_16x16x32_bf16 v[64:67], v[160:163], v[16:19], 0
    v_mfma_f32_16x16x32_bf16 v[68:71], v[176:179], v[16:19], 0
    v_mfma_f32_16x16x32_bf16 v[64:67], v[164:167], v[20:23], v[64:67]
    v_mfma_f32_16x16x32_bf16 v[68:71], v[180:183], v[20:23], v[68:71]
    v_mfma_f32_16x16x32_bf16 v[64:67], v[168:171], v[24:27], v[64:67]
    v_mfma_f32_16x16x32_bf16 v[68:71], v[184:187], v[24:27], v[68:71]
    v_mfma_f32_16x16x32_bf16 v[64:67], v[172:175], v[28:31], v[64:67]
    v_mfma_f32_16x16x32_bf16 v[68:71], v[188:191], v[28:31], v[68:71]
    s_add_u32 s48, s40, 0x38000
    s_add_u32 s49, s40, 0x39000
    buffer_load_dwordx4 v[160:163], v6, s[24:27], s48 offen offset:0 nt
    buffer_load_dwordx4 v[164:167], v6, s[24:27], s48 offen offset:256 nt
    buffer_load_dwordx4 v[168:171], v6, s[24:27], s48 offen offset:512 nt
    buffer_load_dwordx4 v[172:175], v6, s[24:27], s48 offen offset:768 nt
    buffer_load_dwordx4 v[176:179], v6, s[24:27], s49 offen offset:0 nt
    buffer_load_dwordx4 v[180:183], v6, s[24:27], s49 offen offset:256 nt
    buffer_load_dwordx4 v[184:187], v6, s[24:27], s49 offen offset:512 nt
    buffer_load_dwordx4 v[188:191], v6, s[24:27], s49 offen offset:768 nt
    v_max3_f32 v12, v64, v65, v66
    v_max3_f32 v14, v67, v68, v69
    v_max3_f32 v12, v12, v70, v71
    v_max_f32 v12, v12, v14
    v_mov_b32 v13, v12
    s_nop 1
    v_permlane32_swap_b32 v12, v13
    v_max_f32 v12, v12, v13
    v_mov_b32 v13, v12
    s_nop 1
    v_permlane16_swap_b32 v12, v13
    v_max3_f32 v12, v12, v13, v9
    v_cmp_gt_f32 vcc, v12, v9
    s_cbranch_vccz L_nors_a_6
    v_sub_f32 v15, v9, v12
    v_mul_f32 v15, s46, v15
    v_exp_f32 v15, v15
    s_nop 0
    v_mul_f32 v10, v10, v15
    v_mul_f32 v32, v32, v15
    v_mul_f32 v33, v33, v15
    v_mul_f32 v34, v34, v15
    v_mul_f32 v35, v35, v15
    v_mul_f32 v36, v36, v15
    v_mul_f32 v37, v37, v15
    v_mul_f32 v38, v38, v15
    v_mul_f32 v39, v39, v15
    v_mul_f32 v40, v40, v15
    v_mul_f32 v41, v41, v15
    v_mul_f32 v42, v42, v15
    v_mul_f32 v43, v43, v15
    v_mul_f32 v44, v44, v15
    v_mul_f32 v45, v45, v15
    v_mul_f32 v46, v46, v15
    v_mul_f32 v47, v47, v15
    v_mul_f32 v48, v48, v15
    v_mul_f32 v49, v49, v15
    v_mul_f32 v50, v50, v15
    v_mul_f32 v51, v51, v15
    v_mul_f32 v52, v52, v15
    v_mul_f32 v53, v53, v15
    v_mul_f32 v54, v54, v15
    v_mul_f32 v55, v55, v15
    v_mul_f32 v56, v56, v15
    v_mul_f32 v57, v57, v15
    v_mul_f32 v58, v58, v15
    v_mul_f32 v59, v59, v15
    v_mul_f32 v60, v60, v15
    v_mul_f32 v61, v61, v15
    v_mul_f32 v62, v62, v15
    v_mul_f32 v63, v63, v15
L_nors_a_6:
    v_mov_b32 v9, v12
    v_mul_f32 v11, s46, v12
    v_fma_f32 v64, v64, s46, -v11
    v_fma_f32 v65, v65, s46, -v11
    v_fma_f32 v66, v66, s46, -v11
    v_fma_f32 v67, v67, s46, -v11
    v_fma_f32 v68, v68, s46, -v11
    v_fma_f32 v69, v69, s46, -v11
    v_fma_f32 v70, v70, s46, -v11
    v_fma_f32 v71, v71, s46, -v11
    v_exp_f32 v64, v64
    v_exp_f32 v65, v65
    v_exp_f32 v66, v66
    v_exp_f32 v67, v67
    v_exp_f32 v68, v68
    v_exp_f32 v69, v69
    v_exp_f32 v70, v70
    v_exp_f32 v71, v71
    s_nop 0
    v_cvt_pk_bf16_f32 v72, v64, v65
    v_cvt_pk_bf16_f32 v73, v66, v67
    v_cvt_pk_bf16_f32 v74, v68, v69
    v_cvt_pk_bf16_f32 v75, v70, v71
    v_add_f32 v10, v10, v64
    v_add_f32 v10, v10, v65
    v_add_f32 v10, v10, v66
    v_add_f32 v10, v10, v67
    v_add_f32 v10, v10, v68
    v_add_f32 v10, v10, v69
    v_add_f32 v10, v10, v70
    v_add_f32 v10, v10, v71
    s_waitcnt vmcnt(32)
    v_perm_b32 v76, v196, v192, s44
    v_perm_b32 v77, v204, v200, s44
    v_perm_b32 v78, v212, v208, s44
    v_perm_b32 v79, v220, v216, s44
    v_perm_b32 v80, v196, v192, s45
    v_perm_b32 v81, v204, v200, s45
    v_perm_b32 v82, v212, v208, s45
    v_perm_b32 v83, v220, v216, s45
    v_perm_b32 v84, v197, v193, s44
    v_perm_b32 v85, v205, v201, s44
    v_perm_b32 v86, v213, v209, s44
    v_perm_b32 v87, v221, v217, s44
    v_perm_b32 v88, v197, v193, s45
    v_perm_b32 v89, v205, v201, s45
    v_perm_b32 v90, v213, v209, s45
    v_perm_b32 v91, v221, v217, s45
    v_mfma_f32_16x16x32_bf16 v[32:35], v[76:79], v[72:75], v[32:35]
    v_mfma_f32_16x16x32_bf16 v[36:39], v[80:83], v[72:75], v[36:39]
    v_perm_b32 v76, v198, v194, s44
    v_perm_b32 v77, v206, v202, s44
    v_perm_b32 v78, v214, v210, s44
    v_perm_b32 v79, v222, v218, s44
    v_perm_b32 v80, v198, v194, s45
    v_perm_b32 v81, v206, v202, s45
    v_perm_b32 v82, v214, v210, s45
    v_perm_b32 v83, v222, v218, s45
    v_mfma_f32_16x16x32_bf16 v[40:43], v[84:87], v[72:75], v[40:43]
    v_mfma_f32_16x16x32_bf16 v[44:47], v[88:91], v[72:75], v[44:47]
    v_perm_b32 v84, v199, v195, s44
    v_perm_b32 v85, v207, v203, s44
    v_perm_b32 v86, v215, v211, s44
    v_perm_b32 v87, v223, v219, s44
    v_perm_b32 v88, v199, v195, s45
    v_perm_b32 v89, v207, v203, s45
    v_perm_b32 v90, v215, v211, s45
    v_perm_b32 v91, v223, v219, s45
    buffer_load_dwordx4 v[192:195], v8, s[32:35], s56 offen offset:0
    buffer_load_dwordx4 v[196:199], v8, s[32:35], s56 offen offset:1024
    buffer_load_dwordx4 v[200:203], v8, s[32:35], s56 offen offset:2048
    buffer_load_dwordx4 v[204:207], v8, s[32:35], s56 offen offset:3072
    buffer_load_dwordx4 v[208:211], v8, s[32:35], s57 offen offset:0
    buffer_load_dwordx4 v[212:215], v8, s[32:35], s57 offen offset:1024
    buffer_load_dwordx4 v[216:219], v8, s[32:35], s57 offen offset:2048
    buffer_load_dwordx4 v[220:223], v8, s[32:35], s57 offen offset:3072
    v_mfma_f32_16x16x32_bf16 v[48:51], v[76:79], v[72:75], v[48:51]
    v_mfma_f32_16x16x32_bf16 v[52:55], v[80:83], v[72:75], v[52:55]
    s_nop 1
    v_mfma_f32_16x16x32_bf16 v[56:59], v[84:87], v[72:75], v[56:59]
    v_mfma_f32_16x16x32_bf16 v[60:63], v[88:91], v[72:75], v[60:63]
    s_waitcnt vmcnt(32)
    v_mfma_f32_16x16x32_bf16 v[64:67], v[224:227], v[16:19], 0
    v_mfma_f32_16x16x32_bf16 v[68:71], v[240:243], v[16:19], 0
    v_mfma_f32_16x16x32_bf16 v[64:67], v[228:231], v[20:23], v[64:67]
    v_mfma_f32_16x16x32_bf16 v[68:71], v[244:247], v[20:23], v[68:71]
    v_mfma_f32_16x16x32_bf16 v[64:67], v[232:235], v[24:27], v[64:67]
    v_mfma_f32_16x16x32_bf16 v[68:71], v[248:251], v[24:27], v[68:71]
    v_mfma_f32_16x16x32_bf16 v[64:67], v[236:239], v[28:31], v[64:67]
    v_mfma_f32_16x16x32_bf16 v[68:71], v[252:255], v[28:31], v[68:71]
    s_nop 7
    s_nop 1
    v_max3_f32 v12, v64, v65, v66
    v_max3_f32 v14, v67, v68, v69
    v_max3_f32 v12, v12, v70, v71
    v_max_f32 v12, v12, v14
    v_mov_b32 v13, v12
    s_nop 1
    v_permlane32_swap_b32 v12, v13
    v_max_f32 v12, v12, v13
    v_mov_b32 v13, v12
    s_nop 1
    v_permlane16_swap_b32 v12, v13
    v_max3_f32 v12, v12, v13, v9
    v_cmp_gt_f32 vcc, v12, v9
    s_cbranch_vccz L_nors_a_7
    v_sub_f32 v15, v9, v12
    v_mul_f32 v15, s46, v15
    v_exp_f32 v15, v15
    s_nop 0
    v_mul_f32 v10, v10, v15
    v_mul_f32 v32, v32, v15
    v_mul_f32 v33, v33, v15
    v_mul_f32 v34, v34, v15
    v_mul_f32 v35, v35, v15
    v_mul_f32 v36, v36, v15
    v_mul_f32 v37, v37, v15
    v_mul_f32 v38, v38, v15
    v_mul_f32 v39, v39, v15
    v_mul_f32 v40, v40, v15
    v_mul_f32 v41, v41, v15
    v_mul_f32 v42, v42, v15
    v_mul_f32 v43, v43, v15
    v_mul_f32 v44, v44, v15
    v_mul_f32 v45, v45, v15
    v_mul_f32 v46, v46, v15
    v_mul_f32 v47, v47, v15
    v_mul_f32 v48, v48, v15
    v_mul_f32 v49, v49, v15
    v_mul_f32 v50, v50, v15
    v_mul_f32 v51, v51, v15
    v_mul_f32 v52, v52, v15
    v_mul_f32 v53, v53, v15
    v_mul_f32 v54, v54, v15
    v_mul_f32 v55, v55, v15
    v_mul_f32 v56, v56, v15
    v_mul_f32 v57, v57, v15
    v_mul_f32 v58, v58, v15
    v_mul_f32 v59, v59, v15
    v_mul_f32 v60, v60, v15
    v_mul_f32 v61, v61, v15
    v_mul_f32 v62, v62, v15
    v_mul_f32 v63, v63, v15
L_nors_a_7:
    v_mov_b32 v9, v12
    v_mul_f32 v11, s46, v12
    v_fma_f32 v64, v64, s46, -v11
    v_fma_f32 v65, v65, s46, -v11
    v_fma_f32 v66, v66, s46, -v11
    v_fma_f32 v67, v67, s46, -v11
    v_fma_f32 v68, v68, s46, -v11
    v_fma_f32 v69, v69, s46, -v11
    v_fma_f32 v70, v70, s46, -v11
    v_fma_f32 v71, v71, s46, -v11
    v_exp_f32 v64, v64
    v_exp_f32 v65, v65
    v_exp_f32 v66, v66
    v_exp_f32 v67, v67
    v_exp_f32 v68, v68
    v_exp_f32 v69, v69
    v_exp_f32 v70, v70
    v_exp_f32 v71, v71
    s_nop 0
    v_cvt_pk_bf16_f32 v72, v64, v65
    v_cvt_pk_bf16_f32 v73, v66, v67
    v_cvt_pk_bf16_f32 v74, v68, v69
    v_cvt_pk_bf16_f32 v75, v70, v71
    v_add_f32 v10, v10, v64
    v_add_f32 v10, v10, v65
    v_add_f32 v10, v10, v66
    v_add_f32 v10, v10, v67
    v_add_f32 v10, v10, v68
    v_add_f32 v10, v10, v69
    v_add_f32 v10, v10, v70
    v_add_f32 v10, v10, v71
    s_waitcnt vmcnt(24)
    v_perm_b32 v76, v100, v96, s44
    v_perm_b32 v77, v108, v104, s44
    v_perm_b32 v78, v116, v112, s44
    v_perm_b32 v79, v124, v120, s44
    v_perm_b32 v80, v100, v96, s45
    v_perm_b32 v81, v108, v104, s45
    v_perm_b32 v82, v116, v112, s45
    v_perm_b32 v83, v124, v120, s45
    v_perm_b32 v84, v101, v97, s44
    v_perm_b32 v85, v109, v105, s44
    v_perm_b32 v86, v117, v113, s44
    v_perm_b32 v87, v125, v121, s44
    v_perm_b32 v88, v101, v97, s45
    v_perm_b32 v89, v109, v105, s45
    v_perm_b32 v90, v117, v113, s45
    v_perm_b32 v91, v125, v121, s45
    v_mfma_f32_16x16x32_bf16 v[32:35], v[76:79], v[72:75], v[32:35]
    v_mfma_f32_16x16x32_bf16 v[36:39], v[80:83], v[72:75], v[36:39]
    v_perm_b32 v76, v102, v98, s44
    v_perm_b32 v77, v110, v106, s44
    v_perm_b32 v78, v118, v114, s44
    v_perm_b32 v79, v126, v122, s44
    v_perm_b32 v80, v102, v98, s45
    v_perm_b32 v81, v110, v106, s45
    v_perm_b32 v82, v118, v114, s45
    v_perm_b32 v83, v126, v122, s45
    v_mfma_f32_16x16x32_bf16 v[40:43], v[84:87], v[72:75], v[40:43]
    v_mfma_f32_16x16x32_bf16 v[44:47], v[88:91], v[72:75], v[44:47]
    v_perm_b32 v84, v103, v99, s44
    v_perm_b32 v85, v111, v107, s44
    v_perm_b32 v86, v119, v115, s44
    v_perm_b32 v87, v127, v123, s44
    v_perm_b32 v88, v103, v99, s45
    v_perm_b32 v89, v111, v107, s45
    v_perm_b32 v90, v119, v115, s45
    v_perm_b32 v91, v127, v123, s45
    v_mfma_f32_16x16x32_bf16 v[48:51], v[76:79], v[72:75], v[48:51]
    v_mfma_f32_16x16x32_bf16 v[52:55], v[80:83], v[72:75], v[52:55]
    s_nop 1
    v_mfma_f32_16x16x32_bf16 v[56:59], v[84:87], v[72:75], v[56:59]
    v_mfma_f32_16x16x32_bf16 v[60:63], v[88:91], v[72:75], v[60:63]
    s_waitcnt vmcnt(16)
    v_mfma_f32_16x16x32_bf16 v[64:67], v[128:131], v[16:19], 0
    v_mfma_f32_16x16x32_bf16 v[68:71], v[144:147], v[16:19], 0
    v_mfma_f32_16x16x32_bf16 v[64:67], v[132:135], v[20:23], v[64:67]
    v_mfma_f32_16x16x32_bf16 v[68:71], v[148:151], v[20:23], v[68:71]
    v_mfma_f32_16x16x32_bf16 v[64:67], v[136:139], v[24:27], v[64:67]
    v_mfma_f32_16x16x32_bf16 v[68:71], v[152:155], v[24:27], v[68:71]
    v_mfma_f32_16x16x32_bf16 v[64:67], v[140:143], v[28:31], v[64:67]
    v_mfma_f32_16x16x32_bf16 v[68:71], v[156:159], v[28:31], v[68:71]
    s_nop 7
    s_nop 1
    v_max3_f32 v12, v64, v65, v66
    v_max3_f32 v14, v67, v68, v69
    v_max3_f32 v12, v12, v70, v71
    v_max_f32 v12, v12, v14
    v_mov_b32 v13, v12
    s_nop 1
    v_permlane32_swap_b32 v12, v13
    v_max_f32 v12, v12, v13
    v_mov_b32 v13, v12
    s_nop 1
    v_permlane16_swap_b32 v12, v13
    v_max3_f32 v12, v12, v13, v9
    v_cmp_gt_f32 vcc, v12, v9
    s_cbranch_vccz L_nors_a_8
    v_sub_f32 v15, v9, v12
    v_mul_f32 v15, s46, v15
    v_exp_f32 v15, v15
    s_nop 0
    v_mul_f32 v10, v10, v15
    v_mul_f32 v32, v32, v15
    v_mul_f32 v33, v33, v15
    v_mul_f32 v34, v34, v15
    v_mul_f32 v35, v35, v15
    v_mul_f32 v36, v36, v15
    v_mul_f32 v37, v37, v15
    v_mul_f32 v38, v38, v15
    v_mul_f32 v39, v39, v15
    v_mul_f32 v40, v40, v15
    v_mul_f32 v41, v41, v15
    v_mul_f32 v42, v42, v15
    v_mul_f32 v43, v43, v15
    v_mul_f32 v44, v44, v15
    v_mul_f32 v45, v45, v15
    v_mul_f32 v46, v46, v15
    v_mul_f32 v47, v47, v15
    v_mul_f32 v48, v48, v15
    v_mul_f32 v49, v49, v15
    v_mul_f32 v50, v50, v15
    v_mul_f32 v51, v51, v15
    v_mul_f32 v52, v52, v15
    v_mul_f32 v53, v53, v15
    v_mul_f32 v54, v54, v15
    v_mul_f32 v55, v55, v15
    v_mul_f32 v56, v56, v15
    v_mul_f32 v57, v57, v15
    v_mul_f32 v58, v58, v15
    v_mul_f32 v59, v59, v15
    v_mul_f32 v60, v60, v15
    v_mul_f32 v61, v61, v15
    v_mul_f32 v62, v62, v15
    v_mul_f32 v63, v63, v15
L_nors_a_8:
    v_mov_b32 v9, v12
    v_mul_f32 v11, s46, v12
    v_fma_f32 v64, v64, s46, -v11
    v_fma_f32 v65, v65, s46, -v11
    v_fma_f32 v66, v66, s46, -v11
    v_fma_f32 v67, v67, s46, -v11
    v_fma_f32 v68, v68, s46, -v11
    v_fma_f32 v69, v69, s46, -v11
    v_fma_f32 v70, v70, s46, -v11
    v_fma_f32 v71, v71, s46, -v11
    v_exp_f32 v64, v64
    v_exp_f32 v65, v65
    v_exp_f32 v66, v66
    v_exp_f32 v67, v67
    v_exp_f32 v68, v68
    v_exp_f32 v69, v69
    v_exp_f32 v70, v70
    v_exp_f32 v71, v71
    s_nop 0
    v_cvt_pk_bf16_f32 v72, v64, v65
    v_cvt_pk_bf16_f32 v73, v66, v67
    v_cvt_pk_bf16_f32 v74, v68, v69
    v_cvt_pk_bf16_f32 v75, v70, v71
    v_add_f32 v10, v10, v64
    v_add_f32 v10, v10, v65
    v_add_f32 v10, v10, v66
    v_add_f32 v10, v10, v67
    v_add_f32 v10, v10, v68
    v_add_f32 v10, v10, v69
    v_add_f32 v10, v10, v70
    v_add_f32 v10, v10, v71
    s_waitcnt vmcnt(8)
    v_perm_b32 v76, v164, v160, s44
    v_perm_b32 v77, v172, v168, s44
    v_perm_b32 v78, v180, v176, s44
    v_perm_b32 v79, v188, v184, s44
    v_perm_b32 v80, v164, v160, s45
    v_perm_b32 v81, v172, v168, s45
    v_perm_b32 v82, v180, v176, s45
    v_perm_b32 v83, v188, v184, s45
    v_perm_b32 v84, v165, v161, s44
    v_perm_b32 v85, v173, v169, s44
    v_perm_b32 v86, v181, v177, s44
    v_perm_b32 v87, v189, v185, s44
    v_perm_b32 v88, v165, v161, s45
    v_perm_b32 v89, v173, v169, s45
    v_perm_b32 v90, v181, v177, s45
    v_perm_b32 v91, v189, v185, s45
    v_mfma_f32_16x16x32_bf16 v[32:35], v[76:79], v[72:75], v[32:35]
    v_mfma_f32_16x16x32_bf16 v[36:39], v[80:83], v[72:75], v[36:39]
    v_perm_b32 v76, v166, v162, s44
    v_perm_b32 v77, v174, v170, s44
    v_perm_b32 v78, v182, v178, s44
    v_perm_b32 v79, v190, v186, s44
    v_perm_b32 v80, v166, v162, s45
    v_perm_b32 v81, v174, v170, s45
    v_perm_b32 v82, v182, v178, s45
    v_perm_b32 v83, v190, v186, s45
    v_mfma_f32_16x16x32_bf16 v[40:43], v[84:87], v[72:75], v[40:43]
    v_mfma_f32_16x16x32_bf16 v[44:47], v[88:91], v[72:75], v[44:47]
    v_perm_b32 v84, v167, v163, s44
    v_perm_b32 v85, v175, v171, s44
    v_perm_b32 v86, v183, v179, s44
    v_perm_b32 v87, v191, v187, s44
    v_perm_b32 v88, v167, v163, s45
    v_perm_b32 v89, v175, v171, s45
    v_perm_b32 v90, v183, v179, s45
    v_perm_b32 v91, v191, v187, s45
    v_mfma_f32_16x16x32_bf16 v[48:51], v[76:79], v[72:75], v[48:51]
    v_mfma_f32_16x16x32_bf16 v[52:55], v[80:83], v[72:75], v[52:55]
    s_nop 1
    v_mfma_f32_16x16x32_bf16 v[56:59], v[84:87], v[72:75], v[56:59]
    v_mfma_f32_16x16x32_bf16 v[60:63], v[88:91], v[72:75], v[60:63]
    v_mov_b32 v13, v10
    s_nop 1
    v_permlane32_swap_b32 v10, v13
    v_add_f32 v10, v10, v13
    v_mov_b32 v13, v10
    s_nop 1
    v_permlane16_swap_b32 v10, v13
    v_add_f32 v10, v10, v13
    v_mov_b32 v12, v9
    v_mov_b32 v13, v10
    s_lshl_b32 s41, s14, 11
    v_lshlrev_b32 v7, 6, v4
    v_lshl_add_u32 v7, v3, 4, v7
    v_add_u32 v7, s41, v7
    s_lshl_b32 s41, s14, 5
    v_lshlrev_b32 v14, 3, v3
    v_add_u32 v14, s41, v14
    v_cmp_gt_u32 vcc, 4, v3
    s_and_saveexec_b64 s[50:51], vcc
    ds_write_b128 v7, v[32:35] offset:0
    ds_write_b128 v7, v[36:39] offset:256
    ds_write_b128 v7, v[40:43] offset:512
    ds_write_b128 v7, v[44:47] offset:768
    ds_write_b128 v7, v[48:51] offset:1024
    ds_write_b128 v7, v[52:55] offset:1280
    ds_write_b128 v7, v[56:59] offset:1536
    ds_write_b128 v7, v[60:63] offset:1792
    ds_write_b64 v14, v[12:13] offset:16384
    s_mov_b64 exec, s[50:51]
    s_waitcnt lgkmcnt(0)
    s_barrier
    s_lshr_b32 s15, s14, 1
    v_bfe_u32 v16, v0, 4, 3
    v_bfe_u32 v17, v0, 2, 2
    v_and_b32 v18, 3, v0
    v_lshlrev_b32 v19, 8, v16
    v_lshl_add_u32 v19, v17, 6, v19
    v_lshl_add_u32 v19, v18, 4, v19
    s_lshl_b32 s41, s15, 13
    v_add_u32 v19, s41, v19
    v_lshlrev_b32 v20, 3, v18
    s_lshl_b32 s41, s15, 7
    v_add_u32 v22, s41, v20
    ds_read_b128 v[32:35], v19 offset:0
    ds_read_b128 v[36:39], v19 offset:2048
    ds_read_b128 v[40:43], v19 offset:4096
    ds_read_b128 v[44:47], v19 offset:6144
    ds_read_b64 v[48:49], v22 offset:16384
    ds_read_b64 v[50:51], v22 offset:16416
    ds_read_b64 v[52:53], v22 offset:16448
    ds_read_b64 v[54:55], v22 offset:16480
    s_waitcnt lgkmcnt(0)
    v_max3_f32 v56, v48, v50, v52
    v_max_f32 v56, v56, v54
    v_sub_f32 v58, v48, v56
    v_mul_f32 v58, s46, v58
    v_exp_f32 v58, v58
    v_sub_f32 v59, v50, v56
    v_mul_f32 v59, s46, v59
    v_exp_f32 v59, v59
    v_sub_f32 v60, v52, v56
    v_mul_f32 v60, s46, v60
    v_exp_f32 v60, v60
    v_sub_f32 v61, v54, v56
    v_mul_f32 v61, s46, v61
    v_exp_f32 v61, v61
    s_nop 0
    v_mul_f32 v57, v58, v49
    v_fmac_f32 v57, v59, v51
    v_fmac_f32 v57, v60, v53
    v_fmac_f32 v57, v61, v55
    v_mul_f32 v64, v58, v32
    v_fmac_f32 v64, v59, v36
    v_fmac_f32 v64, v60, v40
    v_fmac_f32 v64, v61, v44
    v_mul_f32 v65, v58, v33
    v_fmac_f32 v65, v59, v37
    v_fmac_f32 v65, v60, v41
    v_fmac_f32 v65, v61, v45
    v_mul_f32 v66, v58, v34
    v_fmac_f32 v66, v59, v38
    v_fmac_f32 v66, v60, v42
    v_fmac_f32 v66, v61, v46
    v_mul_f32 v67, v58, v35
    v_fmac_f32 v67, v59, v39
    v_fmac_f32 v67, v60, v43
    v_fmac_f32 v67, v61, v47
    s_lshl_b32 s42, s15, 8
    s_add_u32 s42, s42, s2
    s_lshl_b32 s41, s42, 11
    s_add_u32 s41, s41, 0x20000
    v_lshlrev_b32 v21, 9, v18
    v_lshl_add_u32 v21, v16, 6, v21
    v_lshl_add_u32 v21, v17, 4, v21
    buffer_store_dwordx4 v[64:67], v21, s[28:31], s41 offen sc1
    v_and_b32 v23, 127, v0
    v_cmp_gt_u32 vcc, 4, v23
    s_and_saveexec_b64 s[50:51], vcc
    s_lshl_b32 s41, s42, 7
    s_add_u32 s41, s41, 0x10000
    buffer_store_dwordx2 v[56:57], v20, s[28:31], s41 offen sc1
    s_mov_b64 exec, s[50:51]
    s_lshl_b32 s40, s52, 8
    s_add_u32 s40, s40, s16
    v_and_b32 v16, 31, v0
    v_lshlrev_b32 v17, 10, v16
    s_lshl_b32 s41, s40, 7
    s_lshl_b32 s42, s53, 3
    s_add_u32 s41, s41, s42
    s_add_u32 s41, s41, 0x10000
    v_lshrrev_b32 v18, 5, v0
    v_lshlrev_b32 v19, 16, v18
    v_lshl_add_u32 v19, v16, 4, v19
    s_lshl_b32 s84, s40, 11
    s_lshl_b32 s42, s53, 9
    s_add_u32 s84, s84, s42
    s_add_u32 s84, s84, 0x20000
    s_add_u32 s85, s84, 0x4000
    s_add_u32 s86, s84, 0x8000
    s_add_u32 s87, s84, 0xc000
    s_mov_b32 s60, 0
    buffer_load_dwordx2 v[20:21], v17, s[28:31], s41 offen sc1
    buffer_load_dwordx4 v[32:35], v19, s[28:31], s84 offen sc1
    buffer_load_dwordx4 v[36:39], v19, s[28:31], s85 offen sc1
    buffer_load_dwordx4 v[40:43], v19, s[28:31], s86 offen sc1
    buffer_load_dwordx4 v[44:47], v19, s[28:31], s87 offen sc1
    s_waitcnt vmcnt(5)
    v_lshlrev_b32 v96, 16, v192
    v_and_b32 v97, 0xffff0000, v192
    v_lshlrev_b32 v98, 16, v193
    v_and_b32 v99, 0xffff0000, v193
    v_lshlrev_b32 v100, 16, v194
    v_and_b32 v101, 0xffff0000, v194
    v_lshlrev_b32 v102, 16, v195
    v_and_b32 v103, 0xffff0000, v195
    v_lshlrev_b32 v104, 16, v196
    v_and_b32 v105, 0xffff0000, v196
    v_lshlrev_b32 v106, 16, v197
    v_and_b32 v107, 0xffff0000, v197
    v_lshlrev_b32 v108, 16, v198
    v_and_b32 v109, 0xffff0000, v198
    v_lshlrev_b32 v110, 16, v199
    v_and_b32 v111, 0xffff0000, v199
    v_lshlrev_b32 v112, 16, v200
    v_and_b32 v113, 0xffff0000, v200
    v_lshlrev_b32 v114, 16, v201
    v_and_b32 v115, 0xffff0000, v201
    v_lshlrev_b32 v116, 16, v202
    v_and_b32 v117, 0xffff0000, v202
    v_lshlrev_b32 v118, 16, v203
    v_and_b32 v119, 0xffff0000, v203
    v_lshlrev_b32 v120, 16, v204
    v_and_b32 v121, 0xffff0000, v204
    v_lshlrev_b32 v122, 16, v205
    v_and_b32 v123, 0xffff0000, v205
    v_lshlrev_b32 v124, 16, v206
    v_and_b32 v125, 0xffff0000, v206
    v_lshlrev_b32 v126, 16, v207
    v_and_b32 v127, 0xffff0000, v207
    v_lshlrev_b32 v128, 16, v208
    v_and_b32 v129, 0xffff0000, v208
    v_lshlrev_b32 v130, 16, v209
    v_and_b32 v131, 0xffff0000, v209
    v_lshlrev_b32 v132, 16, v210
    v_and_b32 v133, 0xffff0000, v210
    v_lshlrev_b32 v134, 16, v211
    v_and_b32 v135, 0xffff0000, v211
    v_lshlrev_b32 v136, 16, v212
    v_and_b32 v137, 0xffff0000, v212
    v_lshlrev_b32 v138, 16, v213
    v_and_b32 v139, 0xffff0000, v213
    v_lshlrev_b32 v140, 16, v214
    v_and_b32 v141, 0xffff0000, v214
    v_lshlrev_b32 v142, 16, v215
    v_and_b32 v143, 0xffff0000, v215
    v_lshlrev_b32 v144, 16, v216
    v_and_b32 v145, 0xffff0000, v216
    v_lshlrev_b32 v146, 16, v217
    v_and_b32 v147, 0xffff0000, v217
    v_lshlrev_b32 v148, 16, v218
    v_and_b32 v149, 0xffff0000, v218
    v_lshlrev_b32 v150, 16, v219
    v_and_b32 v151, 0xffff0000, v219
    v_lshlrev_b32 v152, 16, v220
    v_and_b32 v153, 0xffff0000, v220
    v_lshlrev_b32 v154, 16, v221
    v_and_b32 v155, 0xffff0000, v221
    v_lshlrev_b32 v156, 16, v222
    v_and_b32 v157, 0xffff0000, v222
    v_lshlrev_b32 v158, 16, v223
    v_and_b32 v159, 0xffff0000, v223
    s_branch L_pchk
L_pml:
    buffer_load_dwordx2 v[20:21], v17, s[28:31], s41 offen sc1
    s_mov_b64 exec, s[62:63]
    s_cbranch_execz L_pskip
    buffer_load_dwordx4 v[32:35], v19, s[28:31], s84 offen sc1
    buffer_load_dwordx4 v[36:39], v19, s[28:31], s85 offen sc1
    buffer_load_dwordx4 v[40:43], v19, s[28:31], s86 offen sc1
    buffer_load_dwordx4 v[44:47], v19, s[28:31], s87 offen sc1
L_pskip:
    s_mov_b64 exec, -1
L_pchk:
    s_waitcnt vmcnt(0)
    v_max3_u32 v22, v32, v33, v34
    v_max3_u32 v22, v22, v35, v36
    v_max3_u32 v22, v22, v37, v38
    v_max3_u32 v22, v22, v39, v40
    v_max3_u32 v22, v22, v41, v42
    v_max3_u32 v22, v22, v43, v44
    v_max3_u32 v22, v22, v45, v46
    v_max_u32 v22, v22, v47
    v_cmp_eq_u32 s[62:63], -1, v22
    v_max_u32 v22, v20, v21
    v_cmp_eq_u32 vcc, -1, v22
    s_or_b64 vcc, vcc, s[62:63]
    s_cbranch_vccz L_pml_done
    s_add_u32 s60, s60, 1
    s_cmp_lt_u32 s60, 0x40000
    s_cbranch_scc0 L_pml_done
    s_sleep 2
    s_branch L_pml
L_pml_done:
    v_mov_b32 v22, v20
    s_nop 1
    v_max_f32_dpp v22, v22, v22 row_ror:1 row_mask:0xf bank_mask:0xf
    s_nop 1
    v_max_f32_dpp v22, v22, v22 row_ror:2 row_mask:0xf bank_mask:0xf
    s_nop 1
    v_max_f32_dpp v22, v22, v22 row_ror:4 row_mask:0xf bank_mask:0xf
    s_nop 1
    v_max_f32_dpp v22, v22, v22 row_ror:8 row_mask:0xf bank_mask:0xf
    v_mov_b32 v23, v22
    s_nop 1
    v_permlane16_swap_b32 v22, v23
    v_max_f32 v22, v22, v23
    v_sub_f32 v20, v20, v22
    v_mul_f32 v20, s46, v20
    v_exp_f32 v20, v20
    s_nop 0
    v_mul_f32 v21, v20, v21
    s_nop 1
    v_add_f32_dpp v21, v21, v21 row_ror:1 row_mask:0xf bank_mask:0xf
    s_nop 1
    v_add_f32_dpp v21, v21, v21 row_ror:2 row_mask:0xf bank_mask:0xf
    s_nop 1
    v_add_f32_dpp v21, v21, v21 row_ror:4 row_mask:0xf bank_mask:0xf
    s_nop 1
    v_add_f32_dpp v21, v21, v21 row_ror:8 row_mask:0xf bank_mask:0xf
    v_mov_b32 v23, v21
    s_nop 1
    v_permlane16_swap_b32 v21, v23
    v_add_f32 v21, v21, v23
    v_rcp_f32 v21, v21
    v_lshlrev_b32 v24, 4, v18
    v_add_u32 v23, 0, v24
    ds_bpermute_b32 v64, v23, v20
    v_add_u32 v23, 4, v24
    ds_bpermute_b32 v65, v23, v20
    v_add_u32 v23, 8, v24
    ds_bpermute_b32 v66, v23, v20
    v_add_u32 v23, 12, v24
    ds_bpermute_b32 v67, v23, v20
    s_waitcnt lgkmcnt(0)
    v_mul_f32 v68, v64, v32
    v_fmac_f32 v68, v65, v36
    v_fmac_f32 v68, v66, v40
    v_fmac_f32 v68, v67, v44
    v_mul_f32 v69, v64, v33
    v_fmac_f32 v69, v65, v37
    v_fmac_f32 v69, v66, v41
    v_fmac_f32 v69, v67, v45
    v_mul_f32 v70, v64, v34
    v_fmac_f32 v70, v65, v38
    v_fmac_f32 v70, v66, v42
    v_fmac_f32 v70, v67, v46
    v_mul_f32 v71, v64, v35
    v_fmac_f32 v71, v65, v39
    v_fmac_f32 v71, v66, v43
    v_fmac_f32 v71, v67, v47
    v_mov_b32 v72, v68
    v_mov_b32 v73, v69
    v_mov_b32 v74, v70
    v_mov_b32 v75, v71
    s_nop 1
    v_permlane32_swap_b32 v68, v72
    v_permlane32_swap_b32 v69, v73
    v_permlane32_swap_b32 v70, v74
    v_permlane32_swap_b32 v71, v75
    v_add_f32 v68, v68, v72
    v_add_f32 v69, v69, v73
    v_add_f32 v70, v70, v74
    v_add_f32 v71, v71, v75
    v_lshlrev_b32 v23, 9, v1
    v_and_b32 v24, 3, v16
    v_lshl_add_u32 v23, v24, 7, v23
    v_lshrrev_b32 v24, 2, v16
    v_lshl_add_u32 v23, v24, 2, v23
    ds_write_b32 v23, v68 offset:20480
    ds_write_b32 v23, v69 offset:20512
    ds_write_b32 v23, v70 offset:20544
    ds_write_b32 v23, v71 offset:20576
    v_lshrrev_b32 v25, 4, v0
    v_lshlrev_b32 v23, 5, v25
    s_waitcnt lgkmcnt(0)
    s_barrier
    ds_read_b128 v[32:35], v23 offset:20480
    ds_read_b128 v[36:39], v23 offset:20496
    ds_read_b128 v[40:43], v23 offset:20992
    ds_read_b128 v[44:47], v23 offset:21008
    ds_read_b128 v[48:51], v23 offset:21504
    ds_read_b128 v[52:55], v23 offset:21520
    ds_read_b128 v[56:59], v23 offset:22016
    ds_read_b128 v[60:63], v23 offset:22032
    s_waitcnt lgkmcnt(0)
    v_add_f32 v32, v32, v40
    v_add_f32 v48, v48, v56
    v_add_f32 v33, v33, v41
    v_add_f32 v49, v49, v57
    v_add_f32 v34, v34, v42
    v_add_f32 v50, v50, v58
    v_add_f32 v35, v35, v43
    v_add_f32 v51, v51, v59
    v_add_f32 v36, v36, v44
    v_add_f32 v52, v52, v60
    v_add_f32 v37, v37, v45
    v_add_f32 v53, v53, v61
    v_add_f32 v38, v38, v46
    v_add_f32 v54, v54, v62
    v_add_f32 v39, v39, v47
    v_add_f32 v55, v55, v63
    v_add_f32 v32, v32, v48
    v_add_f32 v33, v33, v49
    v_add_f32 v34, v34, v50
    v_add_f32 v35, v35, v51
    v_add_f32 v36, v36, v52
    v_add_f32 v37, v37, v53
    v_add_f32 v38, v38, v54
    v_add_f32 v39, v39, v55
    v_mul_f32 v32, v32, v21
    v_mul_f32 v33, v33, v21
    v_mul_f32 v34, v34, v21
    v_mul_f32 v35, v35, v21
    v_mul_f32 v36, v36, v21
    v_mul_f32 v37, v37, v21
    v_mul_f32 v38, v38, v21
    v_mul_f32 v39, v39, v21
    v_cvt_pk_bf16_f32 v32, v32, v32
    v_cvt_pk_bf16_f32 v33, v33, v33
    v_cvt_pk_bf16_f32 v34, v34, v34
    v_cvt_pk_bf16_f32 v35, v35, v35
    v_cvt_pk_bf16_f32 v36, v36, v36
    v_cvt_pk_bf16_f32 v37, v37, v37
    v_cvt_pk_bf16_f32 v38, v38, v38
    v_cvt_pk_bf16_f32 v39, v39, v39
    v_lshlrev_b32 v64, 16, v32
    v_lshlrev_b32 v65, 16, v33
    v_lshlrev_b32 v66, 16, v34
    v_lshlrev_b32 v67, 16, v35
    v_lshlrev_b32 v68, 16, v36
    v_lshlrev_b32 v69, 16, v37
    v_lshlrev_b32 v70, 16, v38
    v_lshlrev_b32 v71, 16, v39
    v_mul_f32 v72, v64, v96
    v_mul_f32 v73, v64, v97
    v_mul_f32 v74, v64, v98
    v_mul_f32 v75, v64, v99
    v_mul_f32 v76, v64, v100
    v_mul_f32 v77, v64, v101
    v_mul_f32 v78, v64, v102
    v_mul_f32 v79, v64, v103
    v_fmac_f32 v72, v65, v104
    v_fmac_f32 v73, v65, v105
    v_fmac_f32 v74, v65, v106
    v_fmac_f32 v75, v65, v107
    v_fmac_f32 v76, v65, v108
    v_fmac_f32 v77, v65, v109
    v_fmac_f32 v78, v65, v110
    v_fmac_f32 v79, v65, v111
    v_fmac_f32 v72, v66, v112
    v_fmac_f32 v73, v66, v113
    v_fmac_f32 v74, v66, v114
    v_fmac_f32 v75, v66, v115
    v_fmac_f32 v76, v66, v116
    v_fmac_f32 v77, v66, v117
    v_fmac_f32 v78, v66, v118
    v_fmac_f32 v79, v66, v119
    v_fmac_f32 v72, v67, v120
    v_fmac_f32 v73, v67, v121
    v_fmac_f32 v74, v67, v122
    v_fmac_f32 v75, v67, v123
    v_fmac_f32 v76, v67, v124
    v_fmac_f32 v77, v67, v125
    v_fmac_f32 v78, v67, v126
    v_fmac_f32 v79, v67, v127
    v_fmac_f32 v72, v68, v128
    v_fmac_f32 v73, v68, v129
    v_fmac_f32 v74, v68, v130
    v_fmac_f32 v75, v68, v131
    v_fmac_f32 v76, v68, v132
    v_fmac_f32 v77, v68, v133
    v_fmac_f32 v78, v68, v134
    v_fmac_f32 v79, v68, v135
    v_fmac_f32 v72, v69, v136
    v_fmac_f32 v73, v69, v137
    v_fmac_f32 v74, v69, v138
    v_fmac_f32 v75, v69, v139
    v_fmac_f32 v76, v69, v140
    v_fmac_f32 v77, v69, v141
    v_fmac_f32 v78, v69, v142
    v_fmac_f32 v79, v69, v143
    v_fmac_f32 v72, v70, v144
    v_fmac_f32 v73, v70, v145
    v_fmac_f32 v74, v70, v146
    v_fmac_f32 v75, v70, v147
    v_fmac_f32 v76, v70, v148
    v_fmac_f32 v77, v70, v149
    v_fmac_f32 v78, v70, v150
    v_fmac_f32 v79, v70, v151
    v_fmac_f32 v72, v71, v152
    v_fmac_f32 v73, v71, v153
    v_fmac_f32 v74, v71, v154
    v_fmac_f32 v75, v71, v155
    v_fmac_f32 v76, v71, v156
    v_fmac_f32 v77, v71, v157
    v_fmac_f32 v78, v71, v158
    v_fmac_f32 v79, v71, v159
    v_mov_b32 v80, v72
    v_mov_b32 v81, v73
    v_mov_b32 v82, v74
    v_mov_b32 v83, v75
    v_mov_b32 v84, v76
    v_mov_b32 v85, v77
    v_mov_b32 v86, v78
    v_mov_b32 v87, v79
    s_nop 1
    v_permlane16_swap_b32 v72, v80
    v_permlane16_swap_b32 v73, v81
    v_permlane16_swap_b32 v74, v82
    v_permlane16_swap_b32 v75, v83
    v_permlane16_swap_b32 v76, v84
    v_permlane16_swap_b32 v77, v85
    v_permlane16_swap_b32 v78, v86
    v_permlane16_swap_b32 v79, v87
    v_add_f32 v72, v72, v80
    v_add_f32 v73, v73, v81
    v_add_f32 v74, v74, v82
    v_add_f32 v75, v75, v83
    v_add_f32 v76, v76, v84
    v_add_f32 v77, v77, v85
    v_add_f32 v78, v78, v86
    v_add_f32 v79, v79, v87
    v_mov_b32 v80, v72
    v_mov_b32 v81, v73
    v_mov_b32 v82, v74
    v_mov_b32 v83, v75
    v_mov_b32 v84, v76
    v_mov_b32 v85, v77
    v_mov_b32 v86, v78
    v_mov_b32 v87, v79
    s_nop 1
    v_permlane32_swap_b32 v72, v80
    v_permlane32_swap_b32 v73, v81
    v_permlane32_swap_b32 v74, v82
    v_permlane32_swap_b32 v75, v83
    v_permlane32_swap_b32 v76, v84
    v_permlane32_swap_b32 v77, v85
    v_permlane32_swap_b32 v78, v86
    v_permlane32_swap_b32 v79, v87
    v_add_f32 v72, v72, v80
    v_add_f32 v73, v73, v81
    v_add_f32 v74, v74, v82
    v_add_f32 v75, v75, v83
    v_add_f32 v76, v76, v84
    v_add_f32 v77, v77, v85
    v_add_f32 v78, v78, v86
    v_add_f32 v79, v79, v87
    v_lshlrev_b32 v23, 9, v1
    v_lshl_add_u32 v23, v3, 5, v23
    ds_write_b128 v23, v[72:75] offset:24576
    ds_write_b128 v23, v[76:79] offset:24592
    s_waitcnt lgkmcnt(0)
    s_barrier
    s_lshl_b32 s40, s52, 2
    s_add_u32 s40, s40, s54
    s_lshl_b32 s41, s40, 14
    s_add_u32 s41, s41, 0x200000
    s_lshl_b32 s42, s55, 9
    s_add_u32 s42, s42, s41
    v_cmp_gt_u32 vcc, 128, v0
    s_and_saveexec_b64 s[50:51], vcc
    v_lshlrev_b32 v23, 2, v0
    ds_read_b32 v68, v23 offset:24576
    ds_read_b32 v69, v23 offset:25088
    ds_read_b32 v70, v23 offset:25600
    ds_read_b32 v71, v23 offset:26112
    s_waitcnt lgkmcnt(0)
    v_add_f32 v68, v68, v69
    v_add_f32 v70, v70, v71
    v_add_f32 v68, v68, v70
    buffer_store_dword v68, v23, s[28:31], s42 offen sc1
    s_mov_b64 exec, s[50:51]
    s_lshl_b32 s43, s40, 2
    s_cmp_lg_u32 s43, s55
    s_cbranch_scc1 L_end
    v_and_b32 v23, 127, v0
    v_lshrrev_b32 v24, 7, v0
    v_lshlrev_b32 v25, 13, v24
    v_lshl_add_u32 v25, v23, 2, v25
    s_add_u32 s42, s41, 4096
    s_mov_b32 s60, 0
L_pf:
    buffer_load_dword v32, v25, s[28:31], s41 offen offset:0 sc1
    buffer_load_dword v33, v25, s[28:31], s41 offen offset:512 sc1
    buffer_load_dword v34, v25, s[28:31], s41 offen offset:1024 sc1
    buffer_load_dword v35, v25, s[28:31], s41 offen offset:1536 sc1
    buffer_load_dword v36, v25, s[28:31], s41 offen offset:2048 sc1
    buffer_load_dword v37, v25, s[28:31], s41 offen offset:2560 sc1
    buffer_load_dword v38, v25, s[28:31], s41 offen offset:3072 sc1
    buffer_load_dword v39, v25, s[28:31], s41 offen offset:3584 sc1
    buffer_load_dword v40, v25, s[28:31], s42 offen offset:0 sc1
    buffer_load_dword v41, v25, s[28:31], s42 offen offset:512 sc1
    buffer_load_dword v42, v25, s[28:31], s42 offen offset:1024 sc1
    buffer_load_dword v43, v25, s[28:31], s42 offen offset:1536 sc1
    buffer_load_dword v44, v25, s[28:31], s42 offen offset:2048 sc1
    buffer_load_dword v45, v25, s[28:31], s42 offen offset:2560 sc1
    buffer_load_dword v46, v25, s[28:31], s42 offen offset:3072 sc1
    buffer_load_dword v47, v25, s[28:31], s42 offen offset:3584 sc1
    s_waitcnt vmcnt(0)
    v_max3_u32 v22, v32, v33, v34
    v_max3_u32 v22, v22, v35, v36
    v_max3_u32 v22, v22, v37, v38
    v_max3_u32 v22, v22, v39, v40
    v_max3_u32 v22, v22, v41, v42
    v_max3_u32 v22, v22, v43, v44
    v_max3_u32 v22, v22, v45, v46
    v_max_u32 v22, v22, v47
    v_cmp_eq_u32 vcc, -1, v22
    s_cbranch_vccz L_pf_done
    s_add_u32 s60, s60, 1
    s_cmp_lt_u32 s60, 0x40000
    s_cbranch_scc0 L_pf_done
    s_sleep 1
    s_branch L_pf
L_pf_done:
    v_add_f32 v32, v32, v33
    v_add_f32 v32, v32, v34
    v_add_f32 v32, v32, v35
    v_add_f32 v32, v32, v36
    v_add_f32 v32, v32, v37
    v_add_f32 v32, v32, v38
    v_add_f32 v32, v32, v39
    v_add_f32 v32, v32, v40
    v_add_f32 v32, v32, v41
    v_add_f32 v32, v32, v42
    v_add_f32 v32, v32, v43
    v_add_f32 v32, v32, v44
    v_add_f32 v32, v32, v45
    v_add_f32 v32, v32, v46
    v_add_f32 v32, v32, v47
    v_lshlrev_b32 v25, 2, v0
    ds_write_b32 v25, v32 offset:26624
    s_waitcnt lgkmcnt(0)
    s_barrier
    v_cmp_gt_u32 vcc, 128, v0
    s_and_saveexec_b64 s[50:51], vcc
    s_cbranch_execz L_end
    ds_read_b32 v33, v25 offset:27136
    s_waitcnt lgkmcnt(0)
    v_add_f32 v32, v32, v33
    v_cvt_pk_bf16_f32 v32, v32, v32
    s_lshl_b32 s43, s40, 8
    v_lshlrev_b32 v25, 1, v0
    buffer_store_short v32, v25, s[72:75], s43 offen
    s_endpgm
L_end:
    s_endpgm
.section .rodata,"a"
.p2align 6
.amdhsa_kernel concat_heads__gqa_block_cached__sliding_block_cached__decode_kernel
  .amdhsa_next_free_vgpr 256
  .amdhsa_next_free_sgpr 102
  .amdhsa_accum_offset 256
  .amdhsa_group_segment_fixed_size 0
  .amdhsa_kernarg_size 104
  .amdhsa_user_sgpr_count 2
  .amdhsa_user_sgpr_kernarg_segment_ptr 1
  .amdhsa_system_sgpr_workgroup_id_x 1
.end_amdhsa_kernel
```
